```python
import torch

def _softmax(x, axis=-1):
    return torch.softmax(x, dim=axis)
def _gelu(x):
    return torch.nn.functional.gelu(x, approximate="tanh")
def _silu(x):
    return torch.nn.functional.silu(x)
def _sigmoid(x):
    return torch.sigmoid(x)
def _layernorm(x, axis=-1, eps=1e-5):
    m = x.mean(dim=axis, keepdim=True)
    v = x.var(dim=axis, keepdim=True, unbiased=False)
    return (x - m) / torch.sqrt(v + eps)
def _scatter_add(tgt, idx, src, axis=0):
    return tgt.clone().index_add_(axis, idx, src)
def _segment_sum(src, seg, n):
    out = torch.zeros((n,) + src.shape[1:], dtype=src.dtype)
    return out.index_add_(0, seg, src)
def _pad(x, pw):
    flat = tuple(v for pair in reversed(pw) for v in pair)
    return torch.nn.functional.pad(x, flat)

kernel_name = 'concat_heads__grouped_kv_mqa__linear_kernel_hedgehog__prompt'

def setup_inputs():

    _w = (lambda a: (lambda t: t.to(torch.bfloat16) if t.is_floating_point() else t)(torch.as_tensor(a)))
    def _A_setup():
        B, S, D, H = 1, 2048, 512, 32
        Dh = D // H
        return {
            "x": _w((lambda *s: torch.randn(*s, dtype=torch.bfloat16) * 0.05)(B, S, D)),
            "wq": _w((lambda *s: torch.randn(*s, dtype=torch.bfloat16) * 1.6)(D, H * Dh)),
            "wk": _w((lambda *s: torch.randn(*s, dtype=torch.bfloat16) * 1.6)(D, Dh)),
            "wv": _w((lambda *s: torch.randn(*s, dtype=torch.bfloat16) * 1.6)(D, Dh)),
            "wo": _w((lambda *s: torch.randn(*s, dtype=torch.bfloat16) * 1.6)(H * Dh, D)),
        }
    _A_in = _A_setup()

    def _B_setup():
        B, S, D, H = 1, 2048, 512, 32
        Dh = D // H
        return {
            "x": _w((lambda *s: torch.randn(*s, dtype=torch.bfloat16) * 0.2)(B, S, D)),
            "wqkv": _w((lambda *s: torch.randn(*s, dtype=torch.bfloat16) * 1.6)(D, 3 * D)),
            "w_phi": _w((lambda *s: torch.randn(*s, dtype=torch.bfloat16) * 1.6)(H, Dh, Dh) * (Dh ** -0.5)),
            "wo": _w((lambda *s: torch.randn(*s, dtype=torch.bfloat16) * 0.8)(D, D)),
        }
    _B_in = _B_setup()

    return {
        "A_x": _A_in["x"],
        "A_wq": _A_in["wq"],
        "A_wk": _A_in["wk"],
        "A_wv": _A_in["wv"],
        "A_wo": _A_in["wo"],
        "B_x": _B_in["x"],
        "B_wqkv": _B_in["wqkv"],
        "B_w_phi": _B_in["w_phi"],
        "B_wo": _B_in["wo"],
    }

def reference(A_x, A_wq, A_wk, A_wv, A_wo, B_x, B_wqkv, B_w_phi, B_wo):
    def _A_ref(x, wq, wk, wv, wo):
        B, S, D = x.shape
        H = 32
        Dh = D // H
        q = (lambda x, *d: x.permute(*d))((x @ wq).reshape(B, S, H, Dh), 0, 2, 1, 3)
        k = x @ wk
        v = x @ wv
        scores = torch.einsum("bhqd,bkd->bhqk", q, k) * (Dh ** -0.5)
        p = _softmax(scores, axis=-1)
        o = torch.einsum("bhqk,bkd->bhqd", p, v)
        return (lambda x, *d: x.permute(*d))(o, 0, 2, 1, 3).reshape(B, S, H * Dh) @ wo

    def _B_ref(x, wqkv, w_phi, wo):
        B, S, D = x.shape
        H = 32; Dh = D // H
        qkv = (lambda x, *d: x.permute(*d))((x @ wqkv).reshape(B, S, 3, H, Dh), 2, 0, 3, 1, 4)
        q, k, v = qkv[0], qkv[1], qkv[2]
        pq = torch.einsum("bhsd,hdf->bhsf", q, w_phi)
        pk = torch.einsum("bhsd,hdf->bhsf", k, w_phi)
        phi_q = torch.concatenate([_softmax(pq, axis=-1), _softmax(-pq, axis=-1)], axis=-1)
        phi_k = torch.concatenate([_softmax(pk, axis=-1), _softmax(-pk, axis=-1)], axis=-1)
        kv = torch.einsum("bhsf,bhsd->bhfd", phi_k, v)
        z  = torch.einsum("bhsf->bhf", phi_k)
        num = torch.einsum("bhqf,bhfd->bhqd", phi_q, kv)
        den = torch.einsum("bhqf,bhf->bhq", phi_q, z)[..., None] + 1e-6
        o = num / den
        return (lambda x, *d: x.permute(*d))(o, 0, 2, 1, 3).reshape(B, S, D) @ wo

    a = _A_ref(A_x, A_wq, A_wk, A_wv, A_wo)
    b = _B_ref(B_x, B_wqkv, B_w_phi, B_wo)
    return torch.concatenate([a, b], axis=-1)
```

```asm
; @launch grid=(256,1,1) block=(512,1,1) lds=163840
.amdgcn_target "amdgcn-amd-amdhsa--gfx950"
.text
.globl concat_heads__grouped_kv_mqa__linear_kernel_hedgehog__prompt_kernel
.p2align 8
.type concat_heads__grouped_kv_mqa__linear_kernel_hedgehog__prompt_kernel,@function
concat_heads__grouped_kv_mqa__linear_kernel_hedgehog__prompt_kernel:
    s_cmp_ge_u32 s2, 256
    s_cbranch_scc1 L_end
    s_load_dwordx16 s[64:79], s[0:1], 0
    s_load_dwordx8 s[80:87], s[0:1], 64
    v_lshrrev_b32 v10, 6, v0
    v_and_b32 v0, 63, v0
    s_and_b32 s3, s2, 7
    v_readfirstlane_b32 s56, v10
    s_lshr_b32 s4, s2, 3
    s_and_b32 s58, s4, 7
    s_lshr_b32 s4, s4, 3
    s_lshl_b32 s3, s3, 2
    s_add_u32 s57, s3, s4
    s_and_b32 s59, s56, 1
    s_bfe_u32 s60, s56, 0x10001
    s_lshl_b32 s61, s56, 10
    s_lshr_b32 s62, s56, 2
    v_lshrrev_b32 v11, 3, v0
    v_lshl_add_u32 v11, v10, 3, v11
    v_and_b32 v12, 7, v0
    v_bfe_u32 v13, v11, 1, 3
    v_xor_b32 v13, v12, v13
    v_lshlrev_b32 v13, 4, v13
    s_lshl_b32 s3, s57, 16
    v_lshl_add_u32 v1, v11, 10, v13
    v_add_u32 v1, s3, v1
    v_bfe_u32 v13, v11, 1, 1
    v_lshlrev_b32 v13, 2, v13
    v_xor_b32 v13, v12, v13
    v_lshlrev_b32 v13, 4, v13
    s_lshl_b32 s3, s58, 7
    v_add_u32 v13, s3, v13
    v_lshl_add_u32 v2, v11, 10, v13
    v_mul_u32_u24 v14, 3072, v11
    v_add_u32 v3, v14, v13
    v_lshlrev_b32 v4, 4, v0
    v_add_u32 v4, s61, v4
    s_waitcnt lgkmcnt(0)
    s_mov_b32 s8, s64
    s_mov_b32 s9, s65
    s_mov_b32 s10, 2097152
    s_mov_b32 s11, 0x00020000
    s_mov_b32 s12, s66
    s_mov_b32 s13, s67
    s_mov_b32 s14, 524288
    s_mov_b32 s15, 0x00020000
    s_mov_b32 s16, s68
    s_mov_b32 s17, s69
    s_mov_b32 s18, 16384
    s_mov_b32 s19, 0x00020000
    s_mov_b32 s20, s70
    s_mov_b32 s21, s71
    s_mov_b32 s22, 16384
    s_mov_b32 s23, 0x00020000
    s_mov_b32 s24, s72
    s_mov_b32 s25, s73
    s_mov_b32 s26, 524288
    s_mov_b32 s27, 0x00020000
    s_mov_b32 s28, s74
    s_mov_b32 s29, s75
    s_mov_b32 s30, 2097152
    s_mov_b32 s31, 0x00020000
    s_mov_b32 s32, s76
    s_mov_b32 s33, s77
    s_mov_b32 s34, 1572864
    s_mov_b32 s35, 0x00020000
    s_mov_b32 s36, s78
    s_mov_b32 s37, s79
    s_mov_b32 s38, 16384
    s_mov_b32 s39, 0x00020000
    s_mov_b32 s40, s80
    s_mov_b32 s41, s81
    s_mov_b32 s42, 524288
    s_mov_b32 s43, 0x00020000
    s_mov_b32 s44, s82
    s_mov_b32 s45, s83
    s_mov_b32 s46, 4194304
    s_mov_b32 s47, 0x00020000
    s_mov_b32 s48, s84
    s_mov_b32 s49, s85
    s_mov_b32 s50, 256
    s_mov_b32 s51, 0x00020000
    s_mov_b32 s52, s86
    s_mov_b32 s53, s87
    s_mov_b32 s54, 8388608
    s_mov_b32 s55, 0x00020000
    s_cmp_lg_u32 s58, 0
    s_cbranch_scc1 L_nokv0
    s_add_u32 m0, s61, 131072
    s_mov_b32 s64, 0
    buffer_load_dwordx4 v4, s[16:19], s64 offen  lds
    s_add_u32 m0, s61, 147456
    s_mov_b32 s64, 0
    buffer_load_dwordx4 v4, s[20:23], s64 offen  lds
    s_add_u32 m0, s61, 139264
    s_mov_b32 s64, 8192
    buffer_load_dwordx4 v4, s[16:19], s64 offen  lds
    s_add_u32 m0, s61, 155648
    s_mov_b32 s64, 8192
    buffer_load_dwordx4 v4, s[20:23], s64 offen  lds
L_nokv0:
    s_add_u32 m0, s61, 0
    s_mov_b32 s64, 0
    buffer_load_dwordx4 v1, s[8:11], s64 offen  lds
    s_add_u32 m0, s61, 8192
    s_mov_b32 s64, 128
    buffer_load_dwordx4 v1, s[8:11], s64 offen  lds
    s_add_u32 m0, s61, 16384
    s_mov_b32 s64, 256
    buffer_load_dwordx4 v1, s[8:11], s64 offen  lds
    s_add_u32 m0, s61, 24576
    s_mov_b32 s64, 384
    buffer_load_dwordx4 v1, s[8:11], s64 offen  lds
    s_add_u32 m0, s61, 32768
    s_mov_b32 s64, 512
    buffer_load_dwordx4 v1, s[8:11], s64 offen  lds
    s_add_u32 m0, s61, 40960
    s_mov_b32 s64, 640
    buffer_load_dwordx4 v1, s[8:11], s64 offen  lds
    s_add_u32 m0, s61, 49152
    s_mov_b32 s64, 768
    buffer_load_dwordx4 v1, s[8:11], s64 offen  lds
    s_add_u32 m0, s61, 57344
    s_mov_b32 s64, 896
    buffer_load_dwordx4 v1, s[8:11], s64 offen  lds
    v_lshrrev_b32 v20, 5, v0
    v_and_b32 v21, 31, v0
    v_lshrrev_b32 v10, 3, v21
    v_and_b32 v11, 3, v0
    v_lshl_add_u32 v10, v10, 2, v11
    v_lshlrev_b32 v10, 1, v10
    v_lshl_add_u32 v10, v20, 7, v10
    s_lshl_b32 s4, s60, 10
    s_add_u32 s4, s4, 106496
    v_add_u32 v16, s4, v10
    v_bfe_u32 v10, v21, 1, 3
    v_xor_b32 v10, v20, v10
    s_lshl_b32 s3, s59, 12
    v_lshlrev_b32 v11, 7, v21
    v_add_u32 v11, s3, v11
    v_xor_b32 v12, 0, v10
    v_lshl_add_u32 v5, v12, 4, v11
    v_xor_b32 v12, 2, v10
    v_lshl_add_u32 v6, v12, 4, v11
    v_xor_b32 v12, 4, v10
    v_lshl_add_u32 v7, v12, 4, v11
    v_xor_b32 v12, 6, v10
    v_lshl_add_u32 v8, v12, 4, v11
    v_bfe_u32 v10, v0, 2, 2
    v_lshl_add_u32 v11, v20, 3, v10
    v_lshrrev_b32 v10, 1, v10
    v_xor_b32 v10, s60, v10
    v_lshlrev_b32 v10, 6, v10
    v_lshl_add_u32 v10, v11, 7, v10
    v_bfe_u32 v12, v0, 4, 1
    v_lshl_add_u32 v10, v12, 5, v10
    v_and_b32 v12, 3, v0
    v_lshl_add_u32 v9, v12, 3, v10
    v_lshlrev_b32 v12, 3, v12
    v_lshl_add_u32 v22, v11, 5, v12
    s_lshl_b32 s3, s60, 14
    s_add_u32 s3, s3, 131072
    v_add_u32 v22, s3, v22
    s_add_u32 s63, s60, 1
    s_cmp_lg_u32 s58, 0
    s_cselect_b32 s63, 3, s63
    s_cmp_eq_u32 s62, 0
    s_cselect_b32 s63, 0, s63
    v_add_u32 v14, 65536, v9
    s_waitcnt vmcnt(4)
    s_barrier
    s_add_u32 m0, s61, 65536
    s_mov_b32 s64, 0
    buffer_load_dwordx4 v2, s[12:15], s64 offen  lds
    s_add_u32 m0, s61, 73728
    s_mov_b32 s64, 65536
    buffer_load_dwordx4 v2, s[12:15], s64 offen  lds
    s_add_u32 m0, s61, 81920
    s_mov_b32 s64, 131072
    buffer_load_dwordx4 v2, s[12:15], s64 offen  lds
    s_add_u32 m0, s61, 90112
    s_mov_b32 s64, 196608
    buffer_load_dwordx4 v2, s[12:15], s64 offen  lds
    s_cmp_eq_u32 s63, 2
    s_cbranch_scc1 L_A0_V
    s_cmp_lg_u32 s63, 1
    s_cbranch_scc1 L_A0_done
    ds_read_b128 v[96:99], v5 offset:0
    ds_read_b64_tr_b16 v[100:101], v22 offset:0
    ds_read_b64_tr_b16 v[102:103], v22 offset:128
    ds_read_b128 v[104:107], v6 offset:0
    ds_read_b64_tr_b16 v[108:109], v22 offset:512
    ds_read_b64_tr_b16 v[110:111], v22 offset:640
    ds_read_b128 v[112:115], v7 offset:0
    ds_read_b64_tr_b16 v[116:117], v22 offset:1024
    ds_read_b64_tr_b16 v[118:119], v22 offset:1152
    ds_read_b128 v[120:123], v8 offset:0
    ds_read_b64_tr_b16 v[124:125], v22 offset:1536
    ds_read_b64_tr_b16 v[126:127], v22 offset:1664
    s_waitcnt lgkmcnt(9)
    v_mfma_f32_32x32x16_bf16 v[64:79], v[100:103], v[96:99], 0
    ds_read_b128 v[96:99], v5 offset:8192
    ds_read_b64_tr_b16 v[100:101], v22 offset:2048
    ds_read_b64_tr_b16 v[102:103], v22 offset:2176
    s_waitcnt lgkmcnt(9)
    v_mfma_f32_32x32x16_bf16 v[80:95], v[108:111], v[104:107], 0
    ds_read_b128 v[104:107], v6 offset:8192
    ds_read_b64_tr_b16 v[108:109], v22 offset:2560
    ds_read_b64_tr_b16 v[110:111], v22 offset:2688
    s_waitcnt lgkmcnt(9)
    v_mfma_f32_32x32x16_bf16 v[64:79], v[116:119], v[112:115], v[64:79]
    ds_read_b128 v[112:115], v7 offset:8192
    ds_read_b64_tr_b16 v[116:117], v22 offset:3072
    ds_read_b64_tr_b16 v[118:119], v22 offset:3200
    s_waitcnt lgkmcnt(9)
    v_mfma_f32_32x32x16_bf16 v[80:95], v[124:127], v[120:123], v[80:95]
    ds_read_b128 v[120:123], v8 offset:8192
    ds_read_b64_tr_b16 v[124:125], v22 offset:3584
    ds_read_b64_tr_b16 v[126:127], v22 offset:3712
    s_waitcnt lgkmcnt(9)
    v_mfma_f32_32x32x16_bf16 v[64:79], v[100:103], v[96:99], v[64:79]
    ds_read_b128 v[96:99], v5 offset:16384
    ds_read_b64_tr_b16 v[100:101], v22 offset:4096
    ds_read_b64_tr_b16 v[102:103], v22 offset:4224
    s_waitcnt lgkmcnt(9)
    v_mfma_f32_32x32x16_bf16 v[80:95], v[108:111], v[104:107], v[80:95]
    ds_read_b128 v[104:107], v6 offset:16384
    ds_read_b64_tr_b16 v[108:109], v22 offset:4608
    ds_read_b64_tr_b16 v[110:111], v22 offset:4736
    s_waitcnt lgkmcnt(9)
    v_mfma_f32_32x32x16_bf16 v[64:79], v[116:119], v[112:115], v[64:79]
    ds_read_b128 v[112:115], v7 offset:16384
    ds_read_b64_tr_b16 v[116:117], v22 offset:5120
    ds_read_b64_tr_b16 v[118:119], v22 offset:5248
    s_waitcnt lgkmcnt(9)
    v_mfma_f32_32x32x16_bf16 v[80:95], v[124:127], v[120:123], v[80:95]
    ds_read_b128 v[120:123], v8 offset:16384
    ds_read_b64_tr_b16 v[124:125], v22 offset:5632
    ds_read_b64_tr_b16 v[126:127], v22 offset:5760
    s_waitcnt lgkmcnt(9)
    v_mfma_f32_32x32x16_bf16 v[64:79], v[100:103], v[96:99], v[64:79]
    ds_read_b128 v[96:99], v5 offset:24576
    ds_read_b64_tr_b16 v[100:101], v22 offset:6144
    ds_read_b64_tr_b16 v[102:103], v22 offset:6272
    s_waitcnt lgkmcnt(9)
    v_mfma_f32_32x32x16_bf16 v[80:95], v[108:111], v[104:107], v[80:95]
    ds_read_b128 v[104:107], v6 offset:24576
    ds_read_b64_tr_b16 v[108:109], v22 offset:6656
    ds_read_b64_tr_b16 v[110:111], v22 offset:6784
    s_waitcnt lgkmcnt(9)
    v_mfma_f32_32x32x16_bf16 v[64:79], v[116:119], v[112:115], v[64:79]
    ds_read_b128 v[112:115], v7 offset:24576
    ds_read_b64_tr_b16 v[116:117], v22 offset:7168
    ds_read_b64_tr_b16 v[118:119], v22 offset:7296
    s_waitcnt lgkmcnt(9)
    v_mfma_f32_32x32x16_bf16 v[80:95], v[124:127], v[120:123], v[80:95]
    ds_read_b128 v[120:123], v8 offset:24576
    ds_read_b64_tr_b16 v[124:125], v22 offset:7680
    ds_read_b64_tr_b16 v[126:127], v22 offset:7808
    s_waitcnt lgkmcnt(9)
    v_mfma_f32_32x32x16_bf16 v[64:79], v[100:103], v[96:99], v[64:79]
    s_waitcnt lgkmcnt(6)
    v_mfma_f32_32x32x16_bf16 v[80:95], v[108:111], v[104:107], v[80:95]
    s_waitcnt lgkmcnt(3)
    v_mfma_f32_32x32x16_bf16 v[64:79], v[116:119], v[112:115], v[64:79]
    s_waitcnt lgkmcnt(0)
    v_mfma_f32_32x32x16_bf16 v[80:95], v[124:127], v[120:123], v[80:95]
    s_branch L_A0_done
L_A0_V:
    ds_read_b128 v[96:99], v5 offset:0
    ds_read_b64_tr_b16 v[100:101], v22 offset:0
    ds_read_b64_tr_b16 v[102:103], v22 offset:128
    ds_read_b128 v[104:107], v6 offset:0
    ds_read_b64_tr_b16 v[108:109], v22 offset:512
    ds_read_b64_tr_b16 v[110:111], v22 offset:640
    ds_read_b128 v[112:115], v7 offset:0
    ds_read_b64_tr_b16 v[116:117], v22 offset:1024
    ds_read_b64_tr_b16 v[118:119], v22 offset:1152
    ds_read_b128 v[120:123], v8 offset:0
    ds_read_b64_tr_b16 v[124:125], v22 offset:1536
    ds_read_b64_tr_b16 v[126:127], v22 offset:1664
    s_waitcnt lgkmcnt(9)
    v_mfma_f32_32x32x16_bf16 v[64:79], v[96:99], v[100:103], 0
    ds_read_b128 v[96:99], v5 offset:8192
    ds_read_b64_tr_b16 v[100:101], v22 offset:2048
    ds_read_b64_tr_b16 v[102:103], v22 offset:2176
    s_waitcnt lgkmcnt(9)
    v_mfma_f32_32x32x16_bf16 v[80:95], v[104:107], v[108:111], 0
    ds_read_b128 v[104:107], v6 offset:8192
    ds_read_b64_tr_b16 v[108:109], v22 offset:2560
    ds_read_b64_tr_b16 v[110:111], v22 offset:2688
    s_waitcnt lgkmcnt(9)
    v_mfma_f32_32x32x16_bf16 v[64:79], v[112:115], v[116:119], v[64:79]
    ds_read_b128 v[112:115], v7 offset:8192
    ds_read_b64_tr_b16 v[116:117], v22 offset:3072
    ds_read_b64_tr_b16 v[118:119], v22 offset:3200
    s_waitcnt lgkmcnt(9)
    v_mfma_f32_32x32x16_bf16 v[80:95], v[120:123], v[124:127], v[80:95]
    ds_read_b128 v[120:123], v8 offset:8192
    ds_read_b64_tr_b16 v[124:125], v22 offset:3584
    ds_read_b64_tr_b16 v[126:127], v22 offset:3712
    s_waitcnt lgkmcnt(9)
    v_mfma_f32_32x32x16_bf16 v[64:79], v[96:99], v[100:103], v[64:79]
    ds_read_b128 v[96:99], v5 offset:16384
    ds_read_b64_tr_b16 v[100:101], v22 offset:4096
    ds_read_b64_tr_b16 v[102:103], v22 offset:4224
    s_waitcnt lgkmcnt(9)
    v_mfma_f32_32x32x16_bf16 v[80:95], v[104:107], v[108:111], v[80:95]
    ds_read_b128 v[104:107], v6 offset:16384
    ds_read_b64_tr_b16 v[108:109], v22 offset:4608
    ds_read_b64_tr_b16 v[110:111], v22 offset:4736
    s_waitcnt lgkmcnt(9)
    v_mfma_f32_32x32x16_bf16 v[64:79], v[112:115], v[116:119], v[64:79]
    ds_read_b128 v[112:115], v7 offset:16384
    ds_read_b64_tr_b16 v[116:117], v22 offset:5120
    ds_read_b64_tr_b16 v[118:119], v22 offset:5248
    s_waitcnt lgkmcnt(9)
    v_mfma_f32_32x32x16_bf16 v[80:95], v[120:123], v[124:127], v[80:95]
    ds_read_b128 v[120:123], v8 offset:16384
    ds_read_b64_tr_b16 v[124:125], v22 offset:5632
    ds_read_b64_tr_b16 v[126:127], v22 offset:5760
    s_waitcnt lgkmcnt(9)
    v_mfma_f32_32x32x16_bf16 v[64:79], v[96:99], v[100:103], v[64:79]
    ds_read_b128 v[96:99], v5 offset:24576
    ds_read_b64_tr_b16 v[100:101], v22 offset:6144
    ds_read_b64_tr_b16 v[102:103], v22 offset:6272
    s_waitcnt lgkmcnt(9)
    v_mfma_f32_32x32x16_bf16 v[80:95], v[104:107], v[108:111], v[80:95]
    ds_read_b128 v[104:107], v6 offset:24576
    ds_read_b64_tr_b16 v[108:109], v22 offset:6656
    ds_read_b64_tr_b16 v[110:111], v22 offset:6784
    s_waitcnt lgkmcnt(9)
    v_mfma_f32_32x32x16_bf16 v[64:79], v[112:115], v[116:119], v[64:79]
    ds_read_b128 v[112:115], v7 offset:24576
    ds_read_b64_tr_b16 v[116:117], v22 offset:7168
    ds_read_b64_tr_b16 v[118:119], v22 offset:7296
    s_waitcnt lgkmcnt(9)
    v_mfma_f32_32x32x16_bf16 v[80:95], v[120:123], v[124:127], v[80:95]
    ds_read_b128 v[120:123], v8 offset:24576
    ds_read_b64_tr_b16 v[124:125], v22 offset:7680
    ds_read_b64_tr_b16 v[126:127], v22 offset:7808
    s_waitcnt lgkmcnt(9)
    v_mfma_f32_32x32x16_bf16 v[64:79], v[96:99], v[100:103], v[64:79]
    s_waitcnt lgkmcnt(6)
    v_mfma_f32_32x32x16_bf16 v[80:95], v[104:107], v[108:111], v[80:95]
    s_waitcnt lgkmcnt(3)
    v_mfma_f32_32x32x16_bf16 v[64:79], v[112:115], v[116:119], v[64:79]
    s_waitcnt lgkmcnt(0)
    v_mfma_f32_32x32x16_bf16 v[80:95], v[120:123], v[124:127], v[80:95]
L_A0_done:
    s_waitcnt vmcnt(4)
    s_barrier
    s_add_u32 m0, s61, 98304
    s_mov_b32 s64, 262144
    buffer_load_dwordx4 v2, s[12:15], s64 offen  lds
    s_add_u32 m0, s61, 106496
    s_mov_b32 s64, 327680
    buffer_load_dwordx4 v2, s[12:15], s64 offen  lds
    s_add_u32 m0, s61, 114688
    s_mov_b32 s64, 393216
    buffer_load_dwordx4 v2, s[12:15], s64 offen  lds
    s_add_u32 m0, s61, 122880
    s_mov_b32 s64, 458752
    buffer_load_dwordx4 v2, s[12:15], s64 offen  lds
    s_cmp_lg_u32 s58, 0
    s_cbranch_scc1 L_nozero
    s_lshl_b32 s3, s57, 13
    s_add_u32 s4, s3, 6291456
    v_mov_b32 v28, 0
    v_mov_b32 v29, 0
    v_mov_b32 v30, 0
    v_mov_b32 v31, 0
    buffer_store_dwordx4 v[28:31], v4, s[52:55], s4 offen sc1
    s_cmp_lg_u32 s56, 4
    s_cbranch_scc1 L_nozero
    s_lshl_b32 s4, s57, 8
    v_lshlrev_b32 v10, 13, v0
    s_add_u32 s5, s4, 266240
    s_mov_b64 exec, 7
    buffer_store_dword v28, v10, s[52:55], s5 offen sc1
    s_mov_b64 exec, -1
L_nozero:
    v_mov_b32 v18, 0
    s_lshl_b32 s3, s57, 16
    s_lshl_b32 s4, s59, 15
    s_add_u32 s3, s3, s4
    s_lshl_b32 s4, s58, 12
    s_add_u32 s3, s3, s4
    s_lshl_b32 s4, s60, 11
    s_add_u32 s71, s3, s4
    s_lshl_b32 s4, s62, 10
    s_add_u32 s3, s71, s4
    s_add_u32 s70, s3, 1048576
    s_add_u32 s71, s71, 3145728
    v_mov_b32 v24, -1
    v_mov_b32 v25, -1
    v_mov_b32 v26, -1
    v_mov_b32 v27, -1
    v_lshlrev_b32 v10, 4, v0
    buffer_store_dwordx4 v[24:27], v10, s[52:55], s70 offen sc1
    s_cmp_eq_u32 s63, 2
    s_cbranch_scc1 L_A1_V
    s_cmp_lg_u32 s63, 1
    s_cbranch_scc1 L_A1_done
    ds_read_b128 v[96:99], v5 offset:32768
    ds_read_b64_tr_b16 v[100:101], v22 offset:8192
    ds_read_b64_tr_b16 v[102:103], v22 offset:8320
    ds_read_b128 v[104:107], v6 offset:32768
    ds_read_b64_tr_b16 v[108:109], v22 offset:8704
    ds_read_b64_tr_b16 v[110:111], v22 offset:8832
    ds_read_b128 v[112:115], v7 offset:32768
    ds_read_b64_tr_b16 v[116:117], v22 offset:9216
    ds_read_b64_tr_b16 v[118:119], v22 offset:9344
    ds_read_b128 v[120:123], v8 offset:32768
    ds_read_b64_tr_b16 v[124:125], v22 offset:9728
    ds_read_b64_tr_b16 v[126:127], v22 offset:9856
    s_waitcnt lgkmcnt(9)
    v_mfma_f32_32x32x16_bf16 v[64:79], v[100:103], v[96:99], v[64:79]
    ds_read_b128 v[96:99], v5 offset:40960
    ds_read_b64_tr_b16 v[100:101], v22 offset:10240
    ds_read_b64_tr_b16 v[102:103], v22 offset:10368
    s_waitcnt lgkmcnt(9)
    v_mfma_f32_32x32x16_bf16 v[80:95], v[108:111], v[104:107], v[80:95]
    ds_read_b128 v[104:107], v6 offset:40960
    ds_read_b64_tr_b16 v[108:109], v22 offset:10752
    ds_read_b64_tr_b16 v[110:111], v22 offset:10880
    s_waitcnt lgkmcnt(9)
    v_mfma_f32_32x32x16_bf16 v[64:79], v[116:119], v[112:115], v[64:79]
    ds_read_b128 v[112:115], v7 offset:40960
    ds_read_b64_tr_b16 v[116:117], v22 offset:11264
    ds_read_b64_tr_b16 v[118:119], v22 offset:11392
    s_waitcnt lgkmcnt(9)
    v_mfma_f32_32x32x16_bf16 v[80:95], v[124:127], v[120:123], v[80:95]
    ds_read_b128 v[120:123], v8 offset:40960
    ds_read_b64_tr_b16 v[124:125], v22 offset:11776
    ds_read_b64_tr_b16 v[126:127], v22 offset:11904
    s_waitcnt lgkmcnt(9)
    v_mfma_f32_32x32x16_bf16 v[64:79], v[100:103], v[96:99], v[64:79]
    ds_read_b128 v[96:99], v5 offset:49152
    ds_read_b64_tr_b16 v[100:101], v22 offset:12288
    ds_read_b64_tr_b16 v[102:103], v22 offset:12416
    s_waitcnt lgkmcnt(9)
    v_mfma_f32_32x32x16_bf16 v[80:95], v[108:111], v[104:107], v[80:95]
    ds_read_b128 v[104:107], v6 offset:49152
    ds_read_b64_tr_b16 v[108:109], v22 offset:12800
    ds_read_b64_tr_b16 v[110:111], v22 offset:12928
    s_waitcnt lgkmcnt(9)
    v_mfma_f32_32x32x16_bf16 v[64:79], v[116:119], v[112:115], v[64:79]
    ds_read_b128 v[112:115], v7 offset:49152
    ds_read_b64_tr_b16 v[116:117], v22 offset:13312
    ds_read_b64_tr_b16 v[118:119], v22 offset:13440
    s_waitcnt lgkmcnt(9)
    v_mfma_f32_32x32x16_bf16 v[80:95], v[124:127], v[120:123], v[80:95]
    ds_read_b128 v[120:123], v8 offset:49152
    ds_read_b64_tr_b16 v[124:125], v22 offset:13824
    ds_read_b64_tr_b16 v[126:127], v22 offset:13952
    s_waitcnt lgkmcnt(9)
    v_mfma_f32_32x32x16_bf16 v[64:79], v[100:103], v[96:99], v[64:79]
    ds_read_b128 v[96:99], v5 offset:57344
    ds_read_b64_tr_b16 v[100:101], v22 offset:14336
    ds_read_b64_tr_b16 v[102:103], v22 offset:14464
    s_waitcnt lgkmcnt(9)
    v_mfma_f32_32x32x16_bf16 v[80:95], v[108:111], v[104:107], v[80:95]
    ds_read_b128 v[104:107], v6 offset:57344
    ds_read_b64_tr_b16 v[108:109], v22 offset:14848
    ds_read_b64_tr_b16 v[110:111], v22 offset:14976
    s_waitcnt lgkmcnt(9)
    v_mfma_f32_32x32x16_bf16 v[64:79], v[116:119], v[112:115], v[64:79]
    ds_read_b128 v[112:115], v7 offset:57344
    ds_read_b64_tr_b16 v[116:117], v22 offset:15360
    ds_read_b64_tr_b16 v[118:119], v22 offset:15488
    s_waitcnt lgkmcnt(9)
    v_mfma_f32_32x32x16_bf16 v[80:95], v[124:127], v[120:123], v[80:95]
    ds_read_b128 v[120:123], v8 offset:57344
    ds_read_b64_tr_b16 v[124:125], v22 offset:15872
    ds_read_b64_tr_b16 v[126:127], v22 offset:16000
    s_waitcnt lgkmcnt(9)
    v_mfma_f32_32x32x16_bf16 v[64:79], v[100:103], v[96:99], v[64:79]
    s_waitcnt lgkmcnt(6)
    v_mfma_f32_32x32x16_bf16 v[80:95], v[108:111], v[104:107], v[80:95]
    s_waitcnt lgkmcnt(3)
    v_mfma_f32_32x32x16_bf16 v[64:79], v[116:119], v[112:115], v[64:79]
    s_waitcnt lgkmcnt(0)
    v_mfma_f32_32x32x16_bf16 v[80:95], v[124:127], v[120:123], v[80:95]
    s_lshl_b32 s3, s57, 12
    s_lshl_b32 s4, s59, 11
    s_add_u32 s3, s3, s4
    s_nop 8
    v_pk_add_f32 v[64:65], v[64:65], v[80:81]
    v_pk_add_f32 v[66:67], v[66:67], v[82:83]
    v_pk_add_f32 v[68:69], v[68:69], v[84:85]
    v_pk_add_f32 v[70:71], v[70:71], v[86:87]
    s_mov_b32 s4, 0x3eb8aa3b
    v_mul_f32 v64, s4, v64
    v_mul_f32 v65, s4, v65
    v_mul_f32 v66, s4, v66
    v_mul_f32 v67, s4, v67
    v_mul_f32 v68, s4, v68
    v_mul_f32 v69, s4, v69
    v_mul_f32 v70, s4, v70
    v_mul_f32 v71, s4, v71
    v_cvt_pk_bf16_f32 v96, v64, v65
    v_cvt_pk_bf16_f32 v97, v66, v67
    v_cvt_pk_bf16_f32 v98, v68, v69
    v_cvt_pk_bf16_f32 v99, v70, v71
    v_lshlrev_b32 v10, 4, v0
    buffer_store_dwordx4 v[96:99], v10, s[52:55], s3 offen sc1
    s_branch L_A1_done
L_A1_V:
    ds_read_b128 v[96:99], v5 offset:32768
    ds_read_b64_tr_b16 v[100:101], v22 offset:8192
    ds_read_b64_tr_b16 v[102:103], v22 offset:8320
    ds_read_b128 v[104:107], v6 offset:32768
    ds_read_b64_tr_b16 v[108:109], v22 offset:8704
    ds_read_b64_tr_b16 v[110:111], v22 offset:8832
    ds_read_b128 v[112:115], v7 offset:32768
    ds_read_b64_tr_b16 v[116:117], v22 offset:9216
    ds_read_b64_tr_b16 v[118:119], v22 offset:9344
    ds_read_b128 v[120:123], v8 offset:32768
    ds_read_b64_tr_b16 v[124:125], v22 offset:9728
    ds_read_b64_tr_b16 v[126:127], v22 offset:9856
    s_waitcnt lgkmcnt(9)
    v_mfma_f32_32x32x16_bf16 v[64:79], v[96:99], v[100:103], v[64:79]
    ds_read_b128 v[96:99], v5 offset:40960
    ds_read_b64_tr_b16 v[100:101], v22 offset:10240
    ds_read_b64_tr_b16 v[102:103], v22 offset:10368
    s_waitcnt lgkmcnt(9)
    v_mfma_f32_32x32x16_bf16 v[80:95], v[104:107], v[108:111], v[80:95]
    ds_read_b128 v[104:107], v6 offset:40960
    ds_read_b64_tr_b16 v[108:109], v22 offset:10752
    ds_read_b64_tr_b16 v[110:111], v22 offset:10880
    s_waitcnt lgkmcnt(9)
    v_mfma_f32_32x32x16_bf16 v[64:79], v[112:115], v[116:119], v[64:79]
    ds_read_b128 v[112:115], v7 offset:40960
    ds_read_b64_tr_b16 v[116:117], v22 offset:11264
    ds_read_b64_tr_b16 v[118:119], v22 offset:11392
    s_waitcnt lgkmcnt(9)
    v_mfma_f32_32x32x16_bf16 v[80:95], v[120:123], v[124:127], v[80:95]
    ds_read_b128 v[120:123], v8 offset:40960
    ds_read_b64_tr_b16 v[124:125], v22 offset:11776
    ds_read_b64_tr_b16 v[126:127], v22 offset:11904
    s_waitcnt lgkmcnt(9)
    v_mfma_f32_32x32x16_bf16 v[64:79], v[96:99], v[100:103], v[64:79]
    ds_read_b128 v[96:99], v5 offset:49152
    ds_read_b64_tr_b16 v[100:101], v22 offset:12288
    ds_read_b64_tr_b16 v[102:103], v22 offset:12416
    s_waitcnt lgkmcnt(9)
    v_mfma_f32_32x32x16_bf16 v[80:95], v[104:107], v[108:111], v[80:95]
    ds_read_b128 v[104:107], v6 offset:49152
    ds_read_b64_tr_b16 v[108:109], v22 offset:12800
    ds_read_b64_tr_b16 v[110:111], v22 offset:12928
    s_waitcnt lgkmcnt(9)
    v_mfma_f32_32x32x16_bf16 v[64:79], v[112:115], v[116:119], v[64:79]
    ds_read_b128 v[112:115], v7 offset:49152
    ds_read_b64_tr_b16 v[116:117], v22 offset:13312
    ds_read_b64_tr_b16 v[118:119], v22 offset:13440
    s_waitcnt lgkmcnt(9)
    v_mfma_f32_32x32x16_bf16 v[80:95], v[120:123], v[124:127], v[80:95]
    ds_read_b128 v[120:123], v8 offset:49152
    ds_read_b64_tr_b16 v[124:125], v22 offset:13824
    ds_read_b64_tr_b16 v[126:127], v22 offset:13952
    s_waitcnt lgkmcnt(9)
    v_mfma_f32_32x32x16_bf16 v[64:79], v[96:99], v[100:103], v[64:79]
    ds_read_b128 v[96:99], v5 offset:57344
    ds_read_b64_tr_b16 v[100:101], v22 offset:14336
    ds_read_b64_tr_b16 v[102:103], v22 offset:14464
    s_waitcnt lgkmcnt(9)
    v_mfma_f32_32x32x16_bf16 v[80:95], v[104:107], v[108:111], v[80:95]
    ds_read_b128 v[104:107], v6 offset:57344
    ds_read_b64_tr_b16 v[108:109], v22 offset:14848
    ds_read_b64_tr_b16 v[110:111], v22 offset:14976
    s_waitcnt lgkmcnt(9)
    v_mfma_f32_32x32x16_bf16 v[64:79], v[112:115], v[116:119], v[64:79]
    ds_read_b128 v[112:115], v7 offset:57344
    ds_read_b64_tr_b16 v[116:117], v22 offset:15360
    ds_read_b64_tr_b16 v[118:119], v22 offset:15488
    s_waitcnt lgkmcnt(9)
    v_mfma_f32_32x32x16_bf16 v[80:95], v[120:123], v[124:127], v[80:95]
    ds_read_b128 v[120:123], v8 offset:57344
    ds_read_b64_tr_b16 v[124:125], v22 offset:15872
    ds_read_b64_tr_b16 v[126:127], v22 offset:16000
    s_waitcnt lgkmcnt(9)
    v_mfma_f32_32x32x16_bf16 v[64:79], v[96:99], v[100:103], v[64:79]
    s_waitcnt lgkmcnt(6)
    v_mfma_f32_32x32x16_bf16 v[80:95], v[104:107], v[108:111], v[80:95]
    s_waitcnt lgkmcnt(3)
    v_mfma_f32_32x32x16_bf16 v[64:79], v[112:115], v[116:119], v[64:79]
    s_waitcnt lgkmcnt(0)
    v_mfma_f32_32x32x16_bf16 v[80:95], v[120:123], v[124:127], v[80:95]
    s_lshl_b32 s3, s57, 12
    s_lshl_b32 s4, s59, 11
    s_add_u32 s3, s3, s4
    s_nop 8
    v_pk_add_f32 v[64:65], v[64:65], v[80:81]
    v_pk_add_f32 v[66:67], v[66:67], v[82:83]
    v_pk_add_f32 v[68:69], v[68:69], v[84:85]
    v_pk_add_f32 v[70:71], v[70:71], v[86:87]
    v_pk_add_f32 v[72:73], v[72:73], v[88:89]
    v_pk_add_f32 v[74:75], v[74:75], v[90:91]
    v_pk_add_f32 v[76:77], v[76:77], v[92:93]
    v_pk_add_f32 v[78:79], v[78:79], v[94:95]
    v_cvt_pk_bf16_f32 v96, v64, v65
    v_cvt_pk_bf16_f32 v97, v66, v67
    v_cvt_pk_bf16_f32 v98, v68, v69
    v_cvt_pk_bf16_f32 v99, v70, v71
    v_cvt_pk_bf16_f32 v100, v72, v73
    v_cvt_pk_bf16_f32 v101, v74, v75
    v_cvt_pk_bf16_f32 v102, v76, v77
    v_cvt_pk_bf16_f32 v103, v78, v79
    v_and_b32 v10, 15, v0
    v_lshlrev_b32 v10, 4, v10
    v_lshl_add_u32 v10, v20, 8, v10
    buffer_store_dwordx4 v[96:99], v10, s[52:55], s3 offen offset:1024 sc1
    buffer_store_dwordx4 v[100:103], v10, s[52:55], s3 offen offset:1536 sc1
L_A1_done:
    s_waitcnt vmcnt(5)
    s_barrier
    s_add_u32 m0, s61, 131072
    s_mov_b32 s64, 0
    buffer_load_dwordx4 v1, s[28:31], s64 offen  lds
    s_add_u32 m0, s61, 139264
    s_mov_b32 s64, 0
    buffer_load_dwordx4 v3, s[32:35], s64 offen  lds
    s_add_u32 m0, s61, 147456
    s_mov_b32 s64, 1024
    buffer_load_dwordx4 v3, s[32:35], s64 offen  lds
    s_add_u32 m0, s61, 155648
    s_mov_b32 s64, 2048
    buffer_load_dwordx4 v3, s[32:35], s64 offen  lds
    s_cmp_lg_u32 s63, 0
    s_cbranch_scc1 L_A2_done
    ds_read_b128 v[96:99], v5 offset:0
    ds_read_b64_tr_b16 v[100:101], v14 offset:0
    ds_read_b64_tr_b16 v[102:103], v14 offset:512
    ds_read_b128 v[104:107], v6 offset:0
    ds_read_b64_tr_b16 v[108:109], v14 offset:2048
    ds_read_b64_tr_b16 v[110:111], v14 offset:2560
    ds_read_b128 v[112:115], v7 offset:0
    ds_read_b64_tr_b16 v[116:117], v14 offset:4096
    ds_read_b64_tr_b16 v[118:119], v14 offset:4608
    ds_read_b128 v[120:123], v8 offset:0
    ds_read_b64_tr_b16 v[124:125], v14 offset:6144
    ds_read_b64_tr_b16 v[126:127], v14 offset:6656
    s_waitcnt lgkmcnt(9)
    v_mfma_f32_32x32x16_bf16 v[64:79], v[100:103], v[96:99], 0
    ds_read_b128 v[96:99], v5 offset:8192
    ds_read_b64_tr_b16 v[100:101], v14 offset:8192
    ds_read_b64_tr_b16 v[102:103], v14 offset:8704
    s_waitcnt lgkmcnt(9)
    v_mfma_f32_32x32x16_bf16 v[80:95], v[108:111], v[104:107], 0
    ds_read_b128 v[104:107], v6 offset:8192
    ds_read_b64_tr_b16 v[108:109], v14 offset:10240
    ds_read_b64_tr_b16 v[110:111], v14 offset:10752
    s_waitcnt lgkmcnt(9)
    v_mfma_f32_32x32x16_bf16 v[64:79], v[116:119], v[112:115], v[64:79]
    ds_read_b128 v[112:115], v7 offset:8192
    ds_read_b64_tr_b16 v[116:117], v14 offset:12288
    ds_read_b64_tr_b16 v[118:119], v14 offset:12800
    s_waitcnt lgkmcnt(9)
    v_mfma_f32_32x32x16_bf16 v[80:95], v[124:127], v[120:123], v[80:95]
    ds_read_b128 v[120:123], v8 offset:8192
    ds_read_b64_tr_b16 v[124:125], v14 offset:14336
    ds_read_b64_tr_b16 v[126:127], v14 offset:14848
    s_waitcnt lgkmcnt(9)
    v_mfma_f32_32x32x16_bf16 v[64:79], v[100:103], v[96:99], v[64:79]
    ds_read_b128 v[96:99], v5 offset:16384
    ds_read_b64_tr_b16 v[100:101], v14 offset:16384
    ds_read_b64_tr_b16 v[102:103], v14 offset:16896
    s_waitcnt lgkmcnt(9)
    v_mfma_f32_32x32x16_bf16 v[80:95], v[108:111], v[104:107], v[80:95]
    ds_read_b128 v[104:107], v6 offset:16384
    ds_read_b64_tr_b16 v[108:109], v14 offset:18432
    ds_read_b64_tr_b16 v[110:111], v14 offset:18944
    s_waitcnt lgkmcnt(9)
    v_mfma_f32_32x32x16_bf16 v[64:79], v[116:119], v[112:115], v[64:79]
    ds_read_b128 v[112:115], v7 offset:16384
    ds_read_b64_tr_b16 v[116:117], v14 offset:20480
    ds_read_b64_tr_b16 v[118:119], v14 offset:20992
    s_waitcnt lgkmcnt(9)
    v_mfma_f32_32x32x16_bf16 v[80:95], v[124:127], v[120:123], v[80:95]
    ds_read_b128 v[120:123], v8 offset:16384
    ds_read_b64_tr_b16 v[124:125], v14 offset:22528
    ds_read_b64_tr_b16 v[126:127], v14 offset:23040
    s_waitcnt lgkmcnt(9)
    v_mfma_f32_32x32x16_bf16 v[64:79], v[100:103], v[96:99], v[64:79]
    ds_read_b128 v[96:99], v5 offset:24576
    ds_read_b64_tr_b16 v[100:101], v14 offset:24576
    ds_read_b64_tr_b16 v[102:103], v14 offset:25088
    s_waitcnt lgkmcnt(9)
    v_mfma_f32_32x32x16_bf16 v[80:95], v[108:111], v[104:107], v[80:95]
    ds_read_b128 v[104:107], v6 offset:24576
    ds_read_b64_tr_b16 v[108:109], v14 offset:26624
    ds_read_b64_tr_b16 v[110:111], v14 offset:27136
    s_waitcnt lgkmcnt(9)
    v_mfma_f32_32x32x16_bf16 v[64:79], v[116:119], v[112:115], v[64:79]
    ds_read_b128 v[112:115], v7 offset:24576
    ds_read_b64_tr_b16 v[116:117], v14 offset:28672
    ds_read_b64_tr_b16 v[118:119], v14 offset:29184
    s_waitcnt lgkmcnt(9)
    v_mfma_f32_32x32x16_bf16 v[80:95], v[124:127], v[120:123], v[80:95]
    ds_read_b128 v[120:123], v8 offset:24576
    ds_read_b64_tr_b16 v[124:125], v14 offset:30720
    ds_read_b64_tr_b16 v[126:127], v14 offset:31232
    s_waitcnt lgkmcnt(9)
    v_mfma_f32_32x32x16_bf16 v[64:79], v[100:103], v[96:99], v[64:79]
    s_waitcnt lgkmcnt(6)
    v_mfma_f32_32x32x16_bf16 v[80:95], v[108:111], v[104:107], v[80:95]
    s_waitcnt lgkmcnt(3)
    v_mfma_f32_32x32x16_bf16 v[64:79], v[116:119], v[112:115], v[64:79]
    s_waitcnt lgkmcnt(0)
    v_mfma_f32_32x32x16_bf16 v[80:95], v[124:127], v[120:123], v[80:95]
L_A2_done:
    s_waitcnt vmcnt(4)
    s_barrier
    s_lshl_b32 s3, s58, 3
    s_add_u32 s3, s3, s56
    s_cmp_lg_u32 s3, 4
    s_cbranch_scc1 L_noflag
    s_lshl_b32 s3, s57, 2
    v_mov_b32 v10, 1
    s_mov_b64 exec, 1
    buffer_store_dword v10, off, s[48:51], s3 sc1
    s_mov_b64 exec, -1
L_noflag:
    s_add_u32 m0, s61, 0
    s_mov_b32 s64, 128
    buffer_load_dwordx4 v1, s[28:31], s64 offen  lds
    s_add_u32 m0, s61, 8192
    s_mov_b32 s64, 196608
    buffer_load_dwordx4 v3, s[32:35], s64 offen  lds
    s_add_u32 m0, s61, 16384
    s_mov_b32 s64, 197632
    buffer_load_dwordx4 v3, s[32:35], s64 offen  lds
    s_add_u32 m0, s61, 24576
    s_mov_b32 s64, 198656
    buffer_load_dwordx4 v3, s[32:35], s64 offen  lds
    s_add_u32 m0, s61, 65536
    s_mov_b32 s64, 256
    buffer_load_dwordx4 v1, s[28:31], s64 offen  lds
    s_add_u32 m0, s61, 73728
    s_mov_b32 s64, 393216
    buffer_load_dwordx4 v3, s[32:35], s64 offen  lds
    s_add_u32 m0, s61, 81920
    s_mov_b32 s64, 394240
    buffer_load_dwordx4 v3, s[32:35], s64 offen  lds
    s_add_u32 m0, s61, 90112
    s_mov_b32 s64, 395264
    buffer_load_dwordx4 v3, s[32:35], s64 offen  lds
    s_cmp_lg_u32 s63, 0
    s_cbranch_scc1 L_A3_done
    ds_read_b128 v[96:99], v5 offset:32768
    ds_read_b64_tr_b16 v[100:101], v14 offset:32768
    ds_read_b64_tr_b16 v[102:103], v14 offset:33280
    ds_read_b128 v[104:107], v6 offset:32768
    ds_read_b64_tr_b16 v[108:109], v14 offset:34816
    ds_read_b64_tr_b16 v[110:111], v14 offset:35328
    ds_read_b128 v[112:115], v7 offset:32768
    ds_read_b64_tr_b16 v[116:117], v14 offset:36864
    ds_read_b64_tr_b16 v[118:119], v14 offset:37376
    ds_read_b128 v[120:123], v8 offset:32768
    ds_read_b64_tr_b16 v[124:125], v14 offset:38912
    ds_read_b64_tr_b16 v[126:127], v14 offset:39424
    s_waitcnt lgkmcnt(9)
    v_mfma_f32_32x32x16_bf16 v[64:79], v[100:103], v[96:99], v[64:79]
    ds_read_b128 v[96:99], v5 offset:40960
    ds_read_b64_tr_b16 v[100:101], v14 offset:40960
    ds_read_b64_tr_b16 v[102:103], v14 offset:41472
    s_waitcnt lgkmcnt(9)
    v_mfma_f32_32x32x16_bf16 v[80:95], v[108:111], v[104:107], v[80:95]
    ds_read_b128 v[104:107], v6 offset:40960
    ds_read_b64_tr_b16 v[108:109], v14 offset:43008
    ds_read_b64_tr_b16 v[110:111], v14 offset:43520
    s_waitcnt lgkmcnt(9)
    v_mfma_f32_32x32x16_bf16 v[64:79], v[116:119], v[112:115], v[64:79]
    ds_read_b128 v[112:115], v7 offset:40960
    ds_read_b64_tr_b16 v[116:117], v14 offset:45056
    ds_read_b64_tr_b16 v[118:119], v14 offset:45568
    s_waitcnt lgkmcnt(9)
    v_mfma_f32_32x32x16_bf16 v[80:95], v[124:127], v[120:123], v[80:95]
    ds_read_b128 v[120:123], v8 offset:40960
    ds_read_b64_tr_b16 v[124:125], v14 offset:47104
    ds_read_b64_tr_b16 v[126:127], v14 offset:47616
    s_waitcnt lgkmcnt(9)
    v_mfma_f32_32x32x16_bf16 v[64:79], v[100:103], v[96:99], v[64:79]
    ds_read_b128 v[96:99], v5 offset:49152
    ds_read_b64_tr_b16 v[100:101], v14 offset:49152
    ds_read_b64_tr_b16 v[102:103], v14 offset:49664
    s_waitcnt lgkmcnt(9)
    v_mfma_f32_32x32x16_bf16 v[80:95], v[108:111], v[104:107], v[80:95]
    ds_read_b128 v[104:107], v6 offset:49152
    ds_read_b64_tr_b16 v[108:109], v14 offset:51200
    ds_read_b64_tr_b16 v[110:111], v14 offset:51712
    s_waitcnt lgkmcnt(9)
    v_mfma_f32_32x32x16_bf16 v[64:79], v[116:119], v[112:115], v[64:79]
    ds_read_b128 v[112:115], v7 offset:49152
    ds_read_b64_tr_b16 v[116:117], v14 offset:53248
    ds_read_b64_tr_b16 v[118:119], v14 offset:53760
    s_waitcnt lgkmcnt(9)
    v_mfma_f32_32x32x16_bf16 v[80:95], v[124:127], v[120:123], v[80:95]
    ds_read_b128 v[120:123], v8 offset:49152
    ds_read_b64_tr_b16 v[124:125], v14 offset:55296
    ds_read_b64_tr_b16 v[126:127], v14 offset:55808
    s_waitcnt lgkmcnt(9)
    v_mfma_f32_32x32x16_bf16 v[64:79], v[100:103], v[96:99], v[64:79]
    ds_read_b128 v[96:99], v5 offset:57344
    ds_read_b64_tr_b16 v[100:101], v14 offset:57344
    ds_read_b64_tr_b16 v[102:103], v14 offset:57856
    s_waitcnt lgkmcnt(9)
    v_mfma_f32_32x32x16_bf16 v[80:95], v[108:111], v[104:107], v[80:95]
    ds_read_b128 v[104:107], v6 offset:57344
    ds_read_b64_tr_b16 v[108:109], v14 offset:59392
    ds_read_b64_tr_b16 v[110:111], v14 offset:59904
    s_waitcnt lgkmcnt(9)
    v_mfma_f32_32x32x16_bf16 v[64:79], v[116:119], v[112:115], v[64:79]
    ds_read_b128 v[112:115], v7 offset:57344
    ds_read_b64_tr_b16 v[116:117], v14 offset:61440
    ds_read_b64_tr_b16 v[118:119], v14 offset:61952
    s_waitcnt lgkmcnt(9)
    v_mfma_f32_32x32x16_bf16 v[80:95], v[124:127], v[120:123], v[80:95]
    ds_read_b128 v[120:123], v8 offset:57344
    ds_read_b64_tr_b16 v[124:125], v14 offset:63488
    ds_read_b64_tr_b16 v[126:127], v14 offset:64000
    s_waitcnt lgkmcnt(9)
    v_mfma_f32_32x32x16_bf16 v[64:79], v[100:103], v[96:99], v[64:79]
    s_waitcnt lgkmcnt(6)
    v_mfma_f32_32x32x16_bf16 v[80:95], v[108:111], v[104:107], v[80:95]
    s_waitcnt lgkmcnt(3)
    v_mfma_f32_32x32x16_bf16 v[64:79], v[116:119], v[112:115], v[64:79]
    s_waitcnt lgkmcnt(0)
    v_mfma_f32_32x32x16_bf16 v[80:95], v[124:127], v[120:123], v[80:95]
    s_nop 11
    v_pk_add_f32 v[64:65], v[64:65], v[80:81]
    v_pk_add_f32 v[66:67], v[66:67], v[82:83]
    v_pk_add_f32 v[68:69], v[68:69], v[84:85]
    v_pk_add_f32 v[70:71], v[70:71], v[86:87]
    v_pk_add_f32 v[72:73], v[72:73], v[88:89]
    v_pk_add_f32 v[74:75], v[74:75], v[90:91]
    v_pk_add_f32 v[76:77], v[76:77], v[92:93]
    v_pk_add_f32 v[78:79], v[78:79], v[94:95]
    v_cvt_pk_bf16_f32 v32, v64, v65
    v_cvt_pk_bf16_f32 v33, v66, v67
    v_cvt_pk_bf16_f32 v34, v68, v69
    v_cvt_pk_bf16_f32 v35, v70, v71
    v_cvt_pk_bf16_f32 v36, v72, v73
    v_cvt_pk_bf16_f32 v37, v74, v75
    v_cvt_pk_bf16_f32 v38, v76, v77
    v_cvt_pk_bf16_f32 v39, v78, v79
L_A3_done:
    v_and_b32 v15, 0xfff, v4
    v_lshlrev_b32 v15, 1, v15
    v_add_u32 v15, 98304, v15
    s_waitcnt vmcnt(8)
    s_barrier
    s_lshl_b32 s3, s58, 11
    s_add_u32 m0, s61, 106496
    s_mov_b32 s64, s3
    buffer_load_dwordx4 v4, s[36:39], s64 offen  lds
    s_add_u32 m0, s61, 32768
    s_mov_b32 s64, 384
    buffer_load_dwordx4 v1, s[28:31], s64 offen  lds
    s_add_u32 m0, s61, 40960
    s_mov_b32 s64, 589824
    buffer_load_dwordx4 v3, s[32:35], s64 offen  lds
    s_add_u32 m0, s61, 49152
    s_mov_b32 s64, 590848
    buffer_load_dwordx4 v3, s[32:35], s64 offen  lds
    s_add_u32 m0, s61, 57344
    s_mov_b32 s64, 591872
    buffer_load_dwordx4 v3, s[32:35], s64 offen  lds
    v_add_u32 v10, 131072, v5
    v_add_u32 v11, 131072, v6
    v_add_u32 v12, 131072, v7
    v_add_u32 v13, 131072, v8
    v_add_u32 v14, 131072, v9
    s_cmp_lg_u32 s62, 0
    s_cbranch_scc1 L_B0_q
    ds_write_b128 v15, v[32:35]
    ds_write_b128 v15, v[36:39] offset:16
    ds_read_b128 v[220:223], v10 offset:0
    ds_read_b64_tr_b16 v[224:225], v14 offset:16384
    ds_read_b64_tr_b16 v[226:227], v14 offset:16896
    ds_read_b64_tr_b16 v[228:229], v14 offset:24576
    ds_read_b64_tr_b16 v[230:231], v14 offset:25088
    ds_read_b128 v[232:235], v11 offset:0
    ds_read_b64_tr_b16 v[236:237], v14 offset:18432
    ds_read_b64_tr_b16 v[238:239], v14 offset:18944
    ds_read_b64_tr_b16 v[240:241], v14 offset:26624
    ds_read_b64_tr_b16 v[242:243], v14 offset:27136
    ds_read_b128 v[244:247], v12 offset:0
    ds_read_b64_tr_b16 v[248:249], v14 offset:20480
    ds_read_b64_tr_b16 v[250:251], v14 offset:20992
    ds_read_b64_tr_b16 v[252:253], v14 offset:28672
    ds_read_b64_tr_b16 v[254:255], v14 offset:29184
    s_waitcnt lgkmcnt(10)
    v_mfma_f32_32x32x16_bf16 v[160:175], v[224:227], v[220:223], 0
    v_mfma_f32_32x32x16_bf16 v[176:191], v[220:223], v[228:231], 0
    ds_read_b128 v[220:223], v13 offset:0
    ds_read_b64_tr_b16 v[224:225], v14 offset:22528
    ds_read_b64_tr_b16 v[226:227], v14 offset:23040
    ds_read_b64_tr_b16 v[228:229], v14 offset:30720
    ds_read_b64_tr_b16 v[230:231], v14 offset:31232
    s_waitcnt lgkmcnt(10)
    v_mfma_f32_32x32x16_bf16 v[160:175], v[236:239], v[232:235], v[160:175]
    v_mfma_f32_32x32x16_bf16 v[176:191], v[232:235], v[240:243], v[176:191]
    s_waitcnt lgkmcnt(5)
    v_mfma_f32_32x32x16_bf16 v[160:175], v[248:251], v[244:247], v[160:175]
    v_mfma_f32_32x32x16_bf16 v[176:191], v[244:247], v[252:255], v[176:191]
    s_waitcnt lgkmcnt(0)
    v_mfma_f32_32x32x16_bf16 v[160:175], v[224:227], v[220:223], v[160:175]
    v_mfma_f32_32x32x16_bf16 v[176:191], v[220:223], v[228:231], v[176:191]
    s_branch L_B0_done
L_B0_q:
    ds_read_b128 v[220:223], v10 offset:0
    ds_read_b64_tr_b16 v[224:225], v14 offset:8192
    ds_read_b64_tr_b16 v[226:227], v14 offset:8704
    ds_read_b128 v[228:231], v11 offset:0
    ds_read_b64_tr_b16 v[232:233], v14 offset:10240
    ds_read_b64_tr_b16 v[234:235], v14 offset:10752
    ds_read_b128 v[236:239], v12 offset:0
    ds_read_b64_tr_b16 v[240:241], v14 offset:12288
    ds_read_b64_tr_b16 v[242:243], v14 offset:12800
    ds_read_b128 v[244:247], v13 offset:0
    ds_read_b64_tr_b16 v[248:249], v14 offset:14336
    ds_read_b64_tr_b16 v[250:251], v14 offset:14848
    s_waitcnt lgkmcnt(9)
    v_mfma_f32_32x32x16_bf16 v[160:175], v[224:227], v[220:223], 0
    s_waitcnt lgkmcnt(6)
    v_mfma_f32_32x32x16_bf16 v[160:175], v[232:235], v[228:231], v[160:175]
    s_waitcnt lgkmcnt(3)
    v_mfma_f32_32x32x16_bf16 v[160:175], v[240:243], v[236:239], v[160:175]
    s_waitcnt lgkmcnt(0)
    v_mfma_f32_32x32x16_bf16 v[160:175], v[248:251], v[244:247], v[160:175]
L_B0_done:
    s_waitcnt vmcnt(9)
    s_barrier
    s_cmp_lg_u32 s62, 0
    s_cbranch_scc1 L_B1_q
    ds_read_b128 v[220:223], v5 offset:0
    ds_read_b64_tr_b16 v[224:225], v9 offset:16384
    ds_read_b64_tr_b16 v[226:227], v9 offset:16896
    ds_read_b64_tr_b16 v[228:229], v9 offset:24576
    ds_read_b64_tr_b16 v[230:231], v9 offset:25088
    ds_read_b128 v[232:235], v6 offset:0
    ds_read_b64_tr_b16 v[236:237], v9 offset:18432
    ds_read_b64_tr_b16 v[238:239], v9 offset:18944
    ds_read_b64_tr_b16 v[240:241], v9 offset:26624
    ds_read_b64_tr_b16 v[242:243], v9 offset:27136
    ds_read_b128 v[244:247], v7 offset:0
    ds_read_b64_tr_b16 v[248:249], v9 offset:20480
    ds_read_b64_tr_b16 v[250:251], v9 offset:20992
    ds_read_b64_tr_b16 v[252:253], v9 offset:28672
    ds_read_b64_tr_b16 v[254:255], v9 offset:29184
    s_waitcnt lgkmcnt(10)
    v_mfma_f32_32x32x16_bf16 v[160:175], v[224:227], v[220:223], v[160:175]
    v_mfma_f32_32x32x16_bf16 v[176:191], v[220:223], v[228:231], v[176:191]
    ds_read_b128 v[220:223], v8 offset:0
    ds_read_b64_tr_b16 v[224:225], v9 offset:22528
    ds_read_b64_tr_b16 v[226:227], v9 offset:23040
    ds_read_b64_tr_b16 v[228:229], v9 offset:30720
    ds_read_b64_tr_b16 v[230:231], v9 offset:31232
    s_waitcnt lgkmcnt(10)
    v_mfma_f32_32x32x16_bf16 v[160:175], v[236:239], v[232:235], v[160:175]
    v_mfma_f32_32x32x16_bf16 v[176:191], v[232:235], v[240:243], v[176:191]
    s_waitcnt lgkmcnt(5)
    v_mfma_f32_32x32x16_bf16 v[160:175], v[248:251], v[244:247], v[160:175]
    v_mfma_f32_32x32x16_bf16 v[176:191], v[244:247], v[252:255], v[176:191]
    s_waitcnt lgkmcnt(0)
    v_mfma_f32_32x32x16_bf16 v[160:175], v[224:227], v[220:223], v[160:175]
    v_mfma_f32_32x32x16_bf16 v[176:191], v[220:223], v[228:231], v[176:191]
    s_branch L_B1_done
L_B1_q:
    ds_read_b128 v[32:35], v15 offset:0
    ds_read_b128 v[36:39], v15 offset:16
    ds_read_b128 v[220:223], v5 offset:0
    ds_read_b64_tr_b16 v[224:225], v9 offset:8192
    ds_read_b64_tr_b16 v[226:227], v9 offset:8704
    ds_read_b128 v[228:231], v6 offset:0
    ds_read_b64_tr_b16 v[232:233], v9 offset:10240
    ds_read_b64_tr_b16 v[234:235], v9 offset:10752
    ds_read_b128 v[236:239], v7 offset:0
    ds_read_b64_tr_b16 v[240:241], v9 offset:12288
    ds_read_b64_tr_b16 v[242:243], v9 offset:12800
    ds_read_b128 v[244:247], v8 offset:0
    ds_read_b64_tr_b16 v[248:249], v9 offset:14336
    ds_read_b64_tr_b16 v[250:251], v9 offset:14848
    s_waitcnt lgkmcnt(9)
    v_mfma_f32_32x32x16_bf16 v[160:175], v[224:227], v[220:223], v[160:175]
    s_waitcnt lgkmcnt(6)
    v_mfma_f32_32x32x16_bf16 v[160:175], v[232:235], v[228:231], v[160:175]
    s_waitcnt lgkmcnt(3)
    v_mfma_f32_32x32x16_bf16 v[160:175], v[240:243], v[236:239], v[160:175]
    s_waitcnt lgkmcnt(0)
    v_mfma_f32_32x32x16_bf16 v[160:175], v[248:251], v[244:247], v[160:175]
L_B1_done:
    s_waitcnt vmcnt(4)
    s_barrier
    ds_read_u16 v192, v16 offset:0
    ds_read_u16 v193, v16 offset:32
    ds_read_u16 v194, v16 offset:64
    ds_read_u16 v195, v16 offset:96
    ds_read_u16 v196, v16 offset:256
    ds_read_u16 v197, v16 offset:288
    ds_read_u16 v198, v16 offset:320
    ds_read_u16 v199, v16 offset:352
    ds_read_u16 v200, v16 offset:512
    ds_read_u16 v201, v16 offset:544
    ds_read_u16 v202, v16 offset:576
    ds_read_u16 v203, v16 offset:608
    ds_read_u16 v204, v16 offset:768
    ds_read_u16 v205, v16 offset:800
    ds_read_u16 v206, v16 offset:832
    ds_read_u16 v207, v16 offset:864
    v_add_u32 v10, 65536, v5
    v_add_u32 v11, 65536, v6
    v_add_u32 v12, 65536, v7
    v_add_u32 v13, 65536, v8
    v_add_u32 v14, 65536, v9
    s_cmp_lg_u32 s62, 0
    s_cbranch_scc1 L_B2_q
    ds_read_b128 v[220:223], v10 offset:0
    ds_read_b64_tr_b16 v[224:225], v14 offset:16384
    ds_read_b64_tr_b16 v[226:227], v14 offset:16896
    ds_read_b64_tr_b16 v[228:229], v14 offset:24576
    ds_read_b64_tr_b16 v[230:231], v14 offset:25088
    ds_read_b128 v[232:235], v11 offset:0
    ds_read_b64_tr_b16 v[236:237], v14 offset:18432
    ds_read_b64_tr_b16 v[238:239], v14 offset:18944
    ds_read_b64_tr_b16 v[240:241], v14 offset:26624
    ds_read_b64_tr_b16 v[242:243], v14 offset:27136
    ds_read_b128 v[244:247], v12 offset:0
    ds_read_b64_tr_b16 v[248:249], v14 offset:20480
    ds_read_b64_tr_b16 v[250:251], v14 offset:20992
    ds_read_b64_tr_b16 v[252:253], v14 offset:28672
    ds_read_b64_tr_b16 v[254:255], v14 offset:29184
    s_waitcnt lgkmcnt(10)
    v_mfma_f32_32x32x16_bf16 v[160:175], v[224:227], v[220:223], v[160:175]
    v_mfma_f32_32x32x16_bf16 v[176:191], v[220:223], v[228:231], v[176:191]
    ds_read_b128 v[220:223], v13 offset:0
    ds_read_b64_tr_b16 v[224:225], v14 offset:22528
    ds_read_b64_tr_b16 v[226:227], v14 offset:23040
    ds_read_b64_tr_b16 v[228:229], v14 offset:30720
    ds_read_b64_tr_b16 v[230:231], v14 offset:31232
    s_waitcnt lgkmcnt(10)
    v_mfma_f32_32x32x16_bf16 v[160:175], v[236:239], v[232:235], v[160:175]
    v_mfma_f32_32x32x16_bf16 v[176:191], v[232:235], v[240:243], v[176:191]
    s_waitcnt lgkmcnt(5)
    v_mfma_f32_32x32x16_bf16 v[160:175], v[248:251], v[244:247], v[160:175]
    v_mfma_f32_32x32x16_bf16 v[176:191], v[244:247], v[252:255], v[176:191]
    s_waitcnt lgkmcnt(0)
    v_mfma_f32_32x32x16_bf16 v[160:175], v[224:227], v[220:223], v[160:175]
    v_mfma_f32_32x32x16_bf16 v[176:191], v[220:223], v[228:231], v[176:191]
    s_branch L_B2_done
L_B2_q:
    ds_read_b128 v[220:223], v10 offset:0
    ds_read_b64_tr_b16 v[224:225], v14 offset:8192
    ds_read_b64_tr_b16 v[226:227], v14 offset:8704
    ds_read_b128 v[228:231], v11 offset:0
    ds_read_b64_tr_b16 v[232:233], v14 offset:10240
    ds_read_b64_tr_b16 v[234:235], v14 offset:10752
    ds_read_b128 v[236:239], v12 offset:0
    ds_read_b64_tr_b16 v[240:241], v14 offset:12288
    ds_read_b64_tr_b16 v[242:243], v14 offset:12800
    ds_read_b128 v[244:247], v13 offset:0
    ds_read_b64_tr_b16 v[248:249], v14 offset:14336
    ds_read_b64_tr_b16 v[250:251], v14 offset:14848
    s_waitcnt lgkmcnt(9)
    v_mfma_f32_32x32x16_bf16 v[160:175], v[224:227], v[220:223], v[160:175]
    s_waitcnt lgkmcnt(6)
    v_mfma_f32_32x32x16_bf16 v[160:175], v[232:235], v[228:231], v[160:175]
    s_waitcnt lgkmcnt(3)
    v_mfma_f32_32x32x16_bf16 v[160:175], v[240:243], v[236:239], v[160:175]
    s_waitcnt lgkmcnt(0)
    v_mfma_f32_32x32x16_bf16 v[160:175], v[248:251], v[244:247], v[160:175]
L_B2_done:
    s_cmp_lg_u32 s56, 7
    s_cbranch_scc1 L_pd_f1
    v_lshlrev_b32 v17, 2, v21
    s_mov_b32 s65, 0x40000
L_p_f1:
    buffer_load_dword v19, v17, s[48:51], 0 offen sc1
L_pc_f1:
    s_waitcnt vmcnt(0)
    v_cmp_ne_u32 vcc, 1, v19
    s_sub_u32 s65, s65, 1
    s_cbranch_scc1 L_pd_f1
    s_cmp_eq_u64 vcc, 0
    s_cbranch_scc1 L_pd_f1
    s_sleep 12
    s_branch L_p_f1
L_pd_f1:
    s_waitcnt vmcnt(0)
    s_barrier
    s_add_u32 m0, s61, 98304
    s_mov_b32 s64, 0
    buffer_load_dwordx4 v4, s[52:55], s64 offen sc1 lds
    s_add_u32 m0, s61, 106496
    s_mov_b32 s64, 65536
    buffer_load_dwordx4 v4, s[52:55], s64 offen sc1 lds
    s_add_u32 m0, s61, 114688
    s_mov_b32 s64, 8192
    buffer_load_dwordx4 v4, s[52:55], s64 offen sc1 lds
    s_add_u32 m0, s61, 122880
    s_mov_b32 s64, 73728
    buffer_load_dwordx4 v4, s[52:55], s64 offen sc1 lds
    s_add_u32 m0, s61, 0
    s_mov_b32 s64, 512
    buffer_load_dwordx4 v1, s[28:31], s64 offen  lds
    s_add_u32 m0, s61, 8192
    s_mov_b32 s64, 786432
    buffer_load_dwordx4 v3, s[32:35], s64 offen  lds
    s_add_u32 m0, s61, 16384
    s_mov_b32 s64, 787456
    buffer_load_dwordx4 v3, s[32:35], s64 offen  lds
    s_add_u32 m0, s61, 24576
    s_mov_b32 s64, 788480
    buffer_load_dwordx4 v3, s[32:35], s64 offen  lds
    v_add_u32 v10, 32768, v5
    v_add_u32 v11, 32768, v6
    v_add_u32 v12, 32768, v7
    v_add_u32 v13, 32768, v8
    v_add_u32 v14, 32768, v9
    s_cmp_lg_u32 s62, 0
    s_cbranch_scc1 L_B3_q
    ds_read_b128 v[220:223], v10 offset:0
    ds_read_b64_tr_b16 v[224:225], v14 offset:16384
    ds_read_b64_tr_b16 v[226:227], v14 offset:16896
    ds_read_b64_tr_b16 v[228:229], v14 offset:24576
    ds_read_b64_tr_b16 v[230:231], v14 offset:25088
    ds_read_b128 v[232:235], v11 offset:0
    ds_read_b64_tr_b16 v[236:237], v14 offset:18432
    ds_read_b64_tr_b16 v[238:239], v14 offset:18944
    ds_read_b64_tr_b16 v[240:241], v14 offset:26624
    ds_read_b64_tr_b16 v[242:243], v14 offset:27136
    ds_read_b128 v[244:247], v12 offset:0
    ds_read_b64_tr_b16 v[248:249], v14 offset:20480
    ds_read_b64_tr_b16 v[250:251], v14 offset:20992
    ds_read_b64_tr_b16 v[252:253], v14 offset:28672
    ds_read_b64_tr_b16 v[254:255], v14 offset:29184
    s_waitcnt lgkmcnt(10)
    v_mfma_f32_32x32x16_bf16 v[160:175], v[224:227], v[220:223], v[160:175]
    v_mfma_f32_32x32x16_bf16 v[176:191], v[220:223], v[228:231], v[176:191]
    ds_read_b128 v[220:223], v13 offset:0
    ds_read_b64_tr_b16 v[224:225], v14 offset:22528
    ds_read_b64_tr_b16 v[226:227], v14 offset:23040
    ds_read_b64_tr_b16 v[228:229], v14 offset:30720
    ds_read_b64_tr_b16 v[230:231], v14 offset:31232
    s_waitcnt lgkmcnt(10)
    v_mfma_f32_32x32x16_bf16 v[160:175], v[236:239], v[232:235], v[160:175]
    v_mfma_f32_32x32x16_bf16 v[176:191], v[232:235], v[240:243], v[176:191]
    s_waitcnt lgkmcnt(5)
    v_mfma_f32_32x32x16_bf16 v[160:175], v[248:251], v[244:247], v[160:175]
    v_mfma_f32_32x32x16_bf16 v[176:191], v[244:247], v[252:255], v[176:191]
    s_waitcnt lgkmcnt(0)
    v_mfma_f32_32x32x16_bf16 v[160:175], v[224:227], v[220:223], v[160:175]
    v_mfma_f32_32x32x16_bf16 v[176:191], v[220:223], v[228:231], v[176:191]
    s_branch L_B3_done
L_B3_q:
    ds_read_b128 v[220:223], v10 offset:0
    ds_read_b64_tr_b16 v[224:225], v14 offset:8192
    ds_read_b64_tr_b16 v[226:227], v14 offset:8704
    ds_read_b128 v[228:231], v11 offset:0
    ds_read_b64_tr_b16 v[232:233], v14 offset:10240
    ds_read_b64_tr_b16 v[234:235], v14 offset:10752
    ds_read_b128 v[236:239], v12 offset:0
    ds_read_b64_tr_b16 v[240:241], v14 offset:12288
    ds_read_b64_tr_b16 v[242:243], v14 offset:12800
    ds_read_b128 v[244:247], v13 offset:0
    ds_read_b64_tr_b16 v[248:249], v14 offset:14336
    ds_read_b64_tr_b16 v[250:251], v14 offset:14848
    s_waitcnt lgkmcnt(9)
    v_mfma_f32_32x32x16_bf16 v[160:175], v[224:227], v[220:223], v[160:175]
    s_waitcnt lgkmcnt(6)
    v_mfma_f32_32x32x16_bf16 v[160:175], v[232:235], v[228:231], v[160:175]
    s_waitcnt lgkmcnt(3)
    v_mfma_f32_32x32x16_bf16 v[160:175], v[240:243], v[236:239], v[160:175]
    s_waitcnt lgkmcnt(0)
    v_mfma_f32_32x32x16_bf16 v[160:175], v[248:251], v[244:247], v[160:175]
L_B3_done:
    v_bfe_u32 v10, v0, 2, 1
    v_mul_u32_u24 v10, 0x8000, v10
    v_lshl_add_u32 v10, v10, 16, v10
    v_lshl_or_b32 v24, v193, 16, v192
    v_lshl_or_b32 v25, v195, 16, v194
    v_lshl_or_b32 v26, v197, 16, v196
    v_lshl_or_b32 v27, v199, 16, v198
    v_lshl_or_b32 v28, v201, 16, v200
    v_lshl_or_b32 v29, v203, 16, v202
    v_lshl_or_b32 v30, v205, 16, v204
    v_lshl_or_b32 v31, v207, 16, v206
    v_xor_b32 v24, v10, v24
    v_xor_b32 v25, v10, v25
    v_xor_b32 v26, v10, v26
    v_xor_b32 v27, v10, v27
    v_xor_b32 v28, v10, v28
    v_xor_b32 v29, v10, v29
    v_xor_b32 v30, v10, v30
    v_xor_b32 v31, v10, v31
    s_mov_b32 s68, 0xffff
    s_mov_b32 s69, 0xffff
    s_lshl_b32 s3, s62, 13
    s_add_u32 s3, s3, 98304
    v_lshlrev_b32 v10, 4, v0
    v_add_u32 v22, s3, v10
    v_add_u32 v11, 98304, v10
    s_mov_b32 s92, 0x07060302
    v_and_b32 v10, 15, v0
    v_lshlrev_b32 v10, 4, v10
    v_lshl_add_u32 v10, v20, 8, v10
    v_add_u32 v23, s3, v10
    v_mov_b32 v212, 0x3f803f80
    v_mov_b32 v213, 0x3f803f80
    v_mov_b32 v214, 0x3f803f80
    v_mov_b32 v215, 0x3f803f80
    v_mov_b32 v216, 0x3f803f80
    v_mov_b32 v217, 0x3f803f80
    v_mov_b32 v218, 0x3f803f80
    v_mov_b32 v219, 0x3f803f80
    v_mov_b32 v200, 0
    v_mov_b32 v201, 0
    v_mov_b32 v202, 0
    v_mov_b32 v203, 0
    v_mov_b32 v204, 0
    v_mov_b32 v205, 0
    v_mov_b32 v206, 0
    v_mov_b32 v207, 0
    v_mov_b32 v128, 0
    v_mov_b32 v129, 0
    v_mov_b32 v130, 0
    v_mov_b32 v131, 0
    v_mov_b32 v132, 0
    v_mov_b32 v133, 0
    v_mov_b32 v134, 0
    v_mov_b32 v135, 0
    v_mov_b32 v136, 0
    v_mov_b32 v137, 0
    v_mov_b32 v138, 0
    v_mov_b32 v139, 0
    v_mov_b32 v140, 0
    v_mov_b32 v141, 0
    v_mov_b32 v142, 0
    v_mov_b32 v143, 0
    v_mov_b32 v144, 0
    v_mov_b32 v145, 0
    v_mov_b32 v146, 0
    v_mov_b32 v147, 0
    v_mov_b32 v148, 0
    v_mov_b32 v149, 0
    v_mov_b32 v150, 0
    v_mov_b32 v151, 0
    v_mov_b32 v152, 0
    v_mov_b32 v153, 0
    v_mov_b32 v154, 0
    v_mov_b32 v155, 0
    v_mov_b32 v156, 0
    v_mov_b32 v157, 0
    v_mov_b32 v158, 0
    v_mov_b32 v159, 0
    s_mov_b64 s[76:77], s[52:53]
    s_mov_b64 s[78:79], s[54:55]
    s_mov_b64 s[80:81], s[52:53]
    s_mov_b64 s[82:83], s[54:55]
    v_mov_b32 v56, v4
    v_mov_b32 v57, v4
    s_add_u32 s74, s61, 131072
    s_add_u32 s75, s61, 65536
    s_mov_b32 s84, 16384
    s_mov_b32 s85, 81920
    s_mov_b32 s86, 24576
    s_mov_b32 s87, 90112
    s_mov_b32 s88, 32768
    s_mov_b32 s89, 98304
    s_mov_b32 s90, 40960
    s_mov_b32 s91, 106496
    s_waitcnt vmcnt(4)
    s_barrier
    ds_read_b128 v[208:211], v11 offset:0
    s_waitcnt lgkmcnt(0)
    v_mfma_f32_32x32x16_bf16 v[64:79], v[208:211], v[32:35], 0
    v_mfma_f32_32x32x16_bf16 v[80:95], v[208:211], v[36:39], 0
    ds_read_b128 v[208:211], v22 offset:0
    s_add_u32 m0, s61, 32768
    s_mov_b32 s64, 640
    buffer_load_dwordx4 v1, s[28:31], s64 offen  lds
    s_add_u32 m0, s61, 40960
    s_mov_b32 s64, 983040
    buffer_load_dwordx4 v3, s[32:35], s64 offen  lds
    s_add_u32 m0, s61, 49152
    s_mov_b32 s64, 984064
    buffer_load_dwordx4 v3, s[32:35], s64 offen  lds
    s_add_u32 m0, s61, 57344
    s_mov_b32 s64, 985088
    buffer_load_dwordx4 v3, s[32:35], s64 offen  lds
    v_max3_f32 v10, v64, v65, v66
    v_max3_f32 v10, v10, v67, v68
    v_max3_f32 v10, v10, v69, v70
    v_max3_f32 v10, v10, v71, v72
    v_max3_f32 v10, v10, v73, v74
    v_max3_f32 v10, v10, v75, v76
    v_max3_f32 v10, v10, v77, v78
    v_max_f32 v10, v10, v79
    v_max3_f32 v11, v80, v81, v82
    v_max3_f32 v11, v11, v83, v84
    v_max3_f32 v11, v11, v85, v86
    v_max3_f32 v11, v11, v87, v88
    v_max3_f32 v11, v11, v89, v90
    v_max3_f32 v11, v11, v91, v92
    v_max3_f32 v11, v11, v93, v94
    v_max_f32 v11, v11, v95
    v_mov_b32 v12, v10
    s_nop 1
    v_permlane32_swap_b32 v12, v10
    s_nop 1
    v_max_f32 v10, v12, v10
    v_mov_b32 v12, v11
    s_nop 1
    v_permlane32_swap_b32 v12, v11
    s_nop 1
    v_max_f32 v11, v12, v11
    v_sub_f32 v96, 0, v10
    v_sub_f32 v97, 0, v10
    v_sub_f32 v98, 0, v10
    v_sub_f32 v99, 0, v10
    v_sub_f32 v100, 0, v10
    v_sub_f32 v101, 0, v10
    v_sub_f32 v102, 0, v10
    v_sub_f32 v103, 0, v10
    v_sub_f32 v104, 0, v10
    v_sub_f32 v105, 0, v10
    v_sub_f32 v106, 0, v10
    v_sub_f32 v107, 0, v10
    v_sub_f32 v108, 0, v10
    v_sub_f32 v109, 0, v10
    v_sub_f32 v110, 0, v10
    v_sub_f32 v111, 0, v10
    v_sub_f32 v112, 0, v11
    v_sub_f32 v113, 0, v11
    v_sub_f32 v114, 0, v11
    v_sub_f32 v115, 0, v11
    v_sub_f32 v116, 0, v11
    v_sub_f32 v117, 0, v11
    v_sub_f32 v118, 0, v11
    v_sub_f32 v119, 0, v11
    v_sub_f32 v120, 0, v11
    v_sub_f32 v121, 0, v11
    v_sub_f32 v122, 0, v11
    v_sub_f32 v123, 0, v11
    v_sub_f32 v124, 0, v11
    v_sub_f32 v125, 0, v11
    v_sub_f32 v126, 0, v11
    v_sub_f32 v127, 0, v11
    s_waitcnt lgkmcnt(0)
    v_mfma_f32_32x32x16_bf16 v[64:79], v[208:211], v[32:35], v[96:111]
    s_mov_b32 s66, 0
    s_mov_b32 s67, 16384
    s_nop 4
    s_sub_u32 s100, s62, 1
    s_mov_b32 s101, s100
    s_setprio 1
.p2align 6
L_att:
    s_mov_b64 vcc, s[100:101]
    s_cbranch_vccz L_pr0
    s_setprio 2
L_pr0:
    v_mfma_f32_32x32x16_bf16 v[80:95], v[208:211], v[36:39], v[112:127]
    ds_read_b128 v[208:211], v22 offset:2048
    v_exp_f32 v64, v64
    v_exp_f32 v65, v65
    v_exp_f32 v66, v66
    v_cvt_pk_bf16_f32 v192, v64, v65
    v_exp_f32 v67, v67
    v_mfma_f32_32x32x16_bf16 v[144:159], v[212:215], v[200:203], v[144:159]
    v_exp_f32 v68, v68
    v_cvt_pk_bf16_f32 v193, v66, v67
    v_exp_f32 v69, v69
    v_exp_f32 v70, v70
    v_cvt_pk_bf16_f32 v194, v68, v69
    v_exp_f32 v71, v71
    v_mfma_f32_32x32x16_bf16 v[144:159], v[216:219], v[204:207], v[144:159]
    s_mov_b64 exec, s[68:69]
    ds_read_b128 v[212:215], v23 offset:1024
    ds_read_b128 v[216:219], v23 offset:1536
    s_mov_b64 exec, -1
    v_exp_f32 v72, v72
    v_cvt_pk_bf16_f32 v195, v70, v71
    v_exp_f32 v73, v73
    v_exp_f32 v74, v74
    v_cvt_pk_bf16_f32 v196, v72, v73
    v_exp_f32 v75, v75
    v_exp_f32 v76, v76
    v_cvt_pk_bf16_f32 v197, v74, v75
    v_exp_f32 v77, v77
    v_exp_f32 v78, v78
    v_exp_f32 v79, v79
    v_cvt_pk_bf16_f32 v198, v76, v77
    v_cvt_pk_bf16_f32 v199, v78, v79
    s_waitcnt lgkmcnt(0)
    v_mfma_f32_32x32x16_bf16 v[64:79], v[208:211], v[32:35], v[96:111]
    v_exp_f32 v80, v80
    v_exp_f32 v81, v81
    v_exp_f32 v82, v82
    v_cvt_pk_bf16_f32 v200, v80, v81
    v_exp_f32 v83, v83
    v_mfma_f32_32x32x16_bf16 v[128:143], v[212:215], v[192:195], v[128:143]
    v_exp_f32 v84, v84
    v_cvt_pk_bf16_f32 v201, v82, v83
    v_exp_f32 v85, v85
    v_exp_f32 v86, v86
    v_cvt_pk_bf16_f32 v202, v84, v85
    v_exp_f32 v87, v87
    v_mfma_f32_32x32x16_bf16 v[128:143], v[216:219], v[196:199], v[128:143]
    s_bitcmp1_b32 115, s66
    s_cbranch_scc0 L_ld0
    s_add_u32 m0, s74, 0
    s_nop 0
    buffer_load_dwordx4 v56, s[76:79], s84 offen sc1 lds
    s_add_u32 m0, s74, 8192
    s_nop 0
    buffer_load_dwordx4 v57, s[80:83], s85 offen sc1 lds
    s_add_u32 m0, s74, 16384
    s_nop 0
    buffer_load_dwordx4 v57, s[80:83], s86 offen sc1 lds
    s_add_u32 m0, s74, 24576
    s_nop 0
    buffer_load_dwordx4 v57, s[80:83], s87 offen sc1 lds
L_ld0:
    v_exp_f32 v88, v88
    v_cvt_pk_bf16_f32 v203, v86, v87
    v_exp_f32 v89, v89
    v_exp_f32 v90, v90
    v_cvt_pk_bf16_f32 v204, v88, v89
    v_exp_f32 v91, v91
    v_exp_f32 v92, v92
    v_cvt_pk_bf16_f32 v205, v90, v91
    v_exp_f32 v93, v93
    v_exp_f32 v94, v94
    v_exp_f32 v95, v95
    v_cvt_pk_bf16_f32 v206, v92, v93
    v_cvt_pk_bf16_f32 v207, v94, v95
    v_mfma_f32_32x32x16_bf16 v[80:95], v[208:211], v[36:39], v[112:127]
    ds_read_b128 v[208:211], v22 offset:4096
    v_exp_f32 v64, v64
    v_exp_f32 v65, v65
    v_exp_f32 v66, v66
    v_cvt_pk_bf16_f32 v192, v64, v65
    v_exp_f32 v67, v67
    v_mfma_f32_32x32x16_bf16 v[144:159], v[212:215], v[200:203], v[144:159]
    v_exp_f32 v68, v68
    v_cvt_pk_bf16_f32 v193, v66, v67
    v_exp_f32 v69, v69
    v_exp_f32 v70, v70
    v_cvt_pk_bf16_f32 v194, v68, v69
    v_exp_f32 v71, v71
    v_mfma_f32_32x32x16_bf16 v[144:159], v[216:219], v[204:207], v[144:159]
    s_mov_b64 exec, s[68:69]
    ds_read_b128 v[212:215], v23 offset:3072
    ds_read_b128 v[216:219], v23 offset:3584
    s_mov_b64 exec, -1
    v_exp_f32 v72, v72
    v_cvt_pk_bf16_f32 v195, v70, v71
    v_exp_f32 v73, v73
    v_exp_f32 v74, v74
    v_cvt_pk_bf16_f32 v196, v72, v73
    v_exp_f32 v75, v75
    v_exp_f32 v76, v76
    v_cvt_pk_bf16_f32 v197, v74, v75
    v_exp_f32 v77, v77
    v_exp_f32 v78, v78
    v_exp_f32 v79, v79
    v_cvt_pk_bf16_f32 v198, v76, v77
    v_cvt_pk_bf16_f32 v199, v78, v79
    s_waitcnt lgkmcnt(0)
    v_mfma_f32_32x32x16_bf16 v[64:79], v[208:211], v[32:35], v[96:111]
    v_exp_f32 v80, v80
    v_exp_f32 v81, v81
    v_exp_f32 v82, v82
    v_cvt_pk_bf16_f32 v200, v80, v81
    v_exp_f32 v83, v83
    v_mfma_f32_32x32x16_bf16 v[128:143], v[212:215], v[192:195], v[128:143]
    v_exp_f32 v84, v84
    v_cvt_pk_bf16_f32 v201, v82, v83
    v_exp_f32 v85, v85
    v_exp_f32 v86, v86
    v_cvt_pk_bf16_f32 v202, v84, v85
    v_exp_f32 v87, v87
    v_mfma_f32_32x32x16_bf16 v[128:143], v[216:219], v[196:199], v[128:143]
    s_bitcmp1_b32 99, s66
    s_cbranch_scc0 L_ld1
    s_add_u32 m0, s75, 0
    s_nop 0
    buffer_load_dwordx4 v56, s[76:79], s88 offen sc1 lds
    s_add_u32 m0, s75, 8192
    s_nop 0
    buffer_load_dwordx4 v57, s[80:83], s89 offen sc1 lds
    s_add_u32 m0, s75, 16384
    s_nop 0
    buffer_load_dwordx4 v57, s[80:83], s90 offen sc1 lds
    s_add_u32 m0, s75, 24576
    s_nop 0
    buffer_load_dwordx4 v57, s[80:83], s91 offen sc1 lds
L_ld1:
    v_exp_f32 v88, v88
    v_cvt_pk_bf16_f32 v203, v86, v87
    v_exp_f32 v89, v89
    v_exp_f32 v90, v90
    v_cvt_pk_bf16_f32 v204, v88, v89
    v_exp_f32 v91, v91
    v_exp_f32 v92, v92
    v_cvt_pk_bf16_f32 v205, v90, v91
    v_exp_f32 v93, v93
    v_exp_f32 v94, v94
    v_exp_f32 v95, v95
    v_cvt_pk_bf16_f32 v206, v92, v93
    v_cvt_pk_bf16_f32 v207, v94, v95
    s_bitcmp1_b32 184, s66
    s_cbranch_scc1 L_hm
L_mid:
    s_mov_b64 vcc, s[100:101]
    v_mfma_f32_32x32x16_bf16 v[80:95], v[208:211], v[36:39], v[112:127]
    ds_read_b128 v[208:211], v22 offset:6144
    v_exp_f32 v64, v64
    v_exp_f32 v65, v65
    v_exp_f32 v66, v66
    v_cvt_pk_bf16_f32 v192, v64, v65
    v_exp_f32 v67, v67
    v_mfma_f32_32x32x16_bf16 v[144:159], v[212:215], v[200:203], v[144:159]
    v_exp_f32 v68, v68
    v_cvt_pk_bf16_f32 v193, v66, v67
    v_exp_f32 v69, v69
    v_exp_f32 v70, v70
    v_cvt_pk_bf16_f32 v194, v68, v69
    v_exp_f32 v71, v71
    v_mfma_f32_32x32x16_bf16 v[144:159], v[216:219], v[204:207], v[144:159]
    s_mov_b64 exec, s[68:69]
    ds_read_b128 v[212:215], v23 offset:5120
    ds_read_b128 v[216:219], v23 offset:5632
    s_mov_b64 exec, -1
    v_exp_f32 v72, v72
    v_cvt_pk_bf16_f32 v195, v70, v71
    v_exp_f32 v73, v73
    v_exp_f32 v74, v74
    v_cvt_pk_bf16_f32 v196, v72, v73
    v_exp_f32 v75, v75
    v_exp_f32 v76, v76
    v_cvt_pk_bf16_f32 v197, v74, v75
    v_exp_f32 v77, v77
    v_exp_f32 v78, v78
    v_exp_f32 v79, v79
    v_cvt_pk_bf16_f32 v198, v76, v77
    v_cvt_pk_bf16_f32 v199, v78, v79
    s_waitcnt lgkmcnt(0)
    v_mfma_f32_32x32x16_bf16 v[64:79], v[208:211], v[32:35], v[96:111]
    v_exp_f32 v80, v80
    v_exp_f32 v81, v81
    v_exp_f32 v82, v82
    v_cvt_pk_bf16_f32 v200, v80, v81
    v_exp_f32 v83, v83
    v_mfma_f32_32x32x16_bf16 v[128:143], v[212:215], v[192:195], v[128:143]
    v_exp_f32 v84, v84
    v_cvt_pk_bf16_f32 v201, v82, v83
    v_exp_f32 v85, v85
    v_exp_f32 v86, v86
    v_cvt_pk_bf16_f32 v202, v84, v85
    v_exp_f32 v87, v87
    v_mfma_f32_32x32x16_bf16 v[128:143], v[216:219], v[196:199], v[128:143]
    v_exp_f32 v88, v88
    v_cvt_pk_bf16_f32 v203, v86, v87
    v_exp_f32 v89, v89
    v_exp_f32 v90, v90
    v_cvt_pk_bf16_f32 v204, v88, v89
    v_exp_f32 v91, v91
    v_exp_f32 v92, v92
    v_cvt_pk_bf16_f32 v205, v90, v91
    v_exp_f32 v93, v93
    v_exp_f32 v94, v94
    v_exp_f32 v95, v95
    v_cvt_pk_bf16_f32 v206, v92, v93
    v_cvt_pk_bf16_f32 v207, v94, v95
    s_cbranch_vccz L_pr6
    s_setprio 0
L_pr6:
    v_mfma_f32_32x32x16_bf16 v[80:95], v[208:211], v[36:39], v[112:127]
    v_add_u32 v22, s67, v22
    ds_read_b128 v[208:211], v22 offset:0
    v_exp_f32 v64, v64
    v_exp_f32 v65, v65
    v_exp_f32 v66, v66
    v_cvt_pk_bf16_f32 v192, v64, v65
    v_exp_f32 v67, v67
    v_mfma_f32_32x32x16_bf16 v[144:159], v[212:215], v[200:203], v[144:159]
    v_exp_f32 v68, v68
    v_cvt_pk_bf16_f32 v193, v66, v67
    v_exp_f32 v69, v69
    v_exp_f32 v70, v70
    v_cvt_pk_bf16_f32 v194, v68, v69
    v_exp_f32 v71, v71
    v_mfma_f32_32x32x16_bf16 v[144:159], v[216:219], v[204:207], v[144:159]
    s_mov_b64 exec, s[68:69]
    ds_read_b128 v[212:215], v23 offset:7168
    ds_read_b128 v[216:219], v23 offset:7680
    s_mov_b64 exec, -1
    v_exp_f32 v72, v72
    v_cvt_pk_bf16_f32 v195, v70, v71
    v_exp_f32 v73, v73
    v_exp_f32 v74, v74
    v_cvt_pk_bf16_f32 v196, v72, v73
    v_exp_f32 v75, v75
    v_exp_f32 v76, v76
    v_cvt_pk_bf16_f32 v197, v74, v75
    v_exp_f32 v77, v77
    v_exp_f32 v78, v78
    v_exp_f32 v79, v79
    v_cvt_pk_bf16_f32 v198, v76, v77
    v_cvt_pk_bf16_f32 v199, v78, v79
    s_waitcnt lgkmcnt(0)
    v_mfma_f32_32x32x16_bf16 v[64:79], v[208:211], v[32:35], v[96:111]
    v_exp_f32 v80, v80
    v_exp_f32 v81, v81
    v_exp_f32 v82, v82
    v_cvt_pk_bf16_f32 v200, v80, v81
    v_exp_f32 v83, v83
    v_mfma_f32_32x32x16_bf16 v[128:143], v[212:215], v[192:195], v[128:143]
    v_exp_f32 v84, v84
    v_cvt_pk_bf16_f32 v201, v82, v83
    v_exp_f32 v85, v85
    v_exp_f32 v86, v86
    v_cvt_pk_bf16_f32 v202, v84, v85
    v_exp_f32 v87, v87
    v_mfma_f32_32x32x16_bf16 v[128:143], v[216:219], v[196:199], v[128:143]
    v_add_u32 v23, s67, v23
    s_add_u32 s66, s66, 1
    s_cmp_eq_u32 s66, 3
    s_mov_b32 s67, 16384
    s_cselect_b32 s67, 4294885376, s67
    v_exp_f32 v88, v88
    v_cvt_pk_bf16_f32 v203, v86, v87
    v_exp_f32 v89, v89
    v_exp_f32 v90, v90
    v_cvt_pk_bf16_f32 v204, v88, v89
    v_exp_f32 v91, v91
    v_exp_f32 v92, v92
    v_cvt_pk_bf16_f32 v205, v90, v91
    v_exp_f32 v93, v93
    v_exp_f32 v94, v94
    v_exp_f32 v95, v95
    v_cvt_pk_bf16_f32 v206, v92, v93
    v_cvt_pk_bf16_f32 v207, v94, v95
    s_cmp_eq_u32 s66, 3
    s_cbranch_scc1 L_att
    s_cmp_eq_u32 s66, 8
    s_cbranch_scc1 L_h8
    s_cmp_eq_u32 s66, 7
    s_cbranch_scc1 L_h7
    s_cmp_eq_u32 s66, 6
    s_cbranch_scc1 L_h6
    s_cmp_eq_u32 s66, 5
    s_cbranch_scc1 L_h5
    s_cmp_eq_u32 s66, 4
    s_cbranch_scc1 L_h4
    s_cmp_eq_u32 s66, 2
    s_cbranch_scc1 L_h2
    s_waitcnt vmcnt(0)
    s_barrier
    s_cmp_lg_u32 s62, 0
    s_cbranch_scc1 L_B4_q
    ds_read_b128 v[220:223], v5 offset:0
    ds_read_b64_tr_b16 v[224:225], v9 offset:16384
    ds_read_b64_tr_b16 v[226:227], v9 offset:16896
    ds_read_b64_tr_b16 v[228:229], v9 offset:24576
    ds_read_b64_tr_b16 v[230:231], v9 offset:25088
    ds_read_b128 v[232:235], v6 offset:0
    ds_read_b64_tr_b16 v[236:237], v9 offset:18432
    ds_read_b64_tr_b16 v[238:239], v9 offset:18944
    ds_read_b64_tr_b16 v[240:241], v9 offset:26624
    ds_read_b64_tr_b16 v[242:243], v9 offset:27136
    ds_read_b128 v[244:247], v7 offset:0
    ds_read_b64_tr_b16 v[248:249], v9 offset:20480
    ds_read_b64_tr_b16 v[250:251], v9 offset:20992
    ds_read_b64_tr_b16 v[252:253], v9 offset:28672
    ds_read_b64_tr_b16 v[254:255], v9 offset:29184
    s_waitcnt lgkmcnt(10)
    v_mfma_f32_32x32x16_bf16 v[160:175], v[224:227], v[220:223], v[160:175]
    v_mfma_f32_32x32x16_bf16 v[176:191], v[220:223], v[228:231], v[176:191]
    ds_read_b128 v[220:223], v8 offset:0
    ds_read_b64_tr_b16 v[224:225], v9 offset:22528
    ds_read_b64_tr_b16 v[226:227], v9 offset:23040
    ds_read_b64_tr_b16 v[228:229], v9 offset:30720
    ds_read_b64_tr_b16 v[230:231], v9 offset:31232
    s_waitcnt lgkmcnt(10)
    v_mfma_f32_32x32x16_bf16 v[160:175], v[236:239], v[232:235], v[160:175]
    v_mfma_f32_32x32x16_bf16 v[176:191], v[232:235], v[240:243], v[176:191]
    ds_read_b128 v[232:235], v5 offset:32768
    ds_read_b64_tr_b16 v[236:237], v9 offset:49152
    ds_read_b64_tr_b16 v[238:239], v9 offset:49664
    ds_read_b64_tr_b16 v[240:241], v9 offset:57344
    ds_read_b64_tr_b16 v[242:243], v9 offset:57856
    s_waitcnt lgkmcnt(10)
    v_mfma_f32_32x32x16_bf16 v[160:175], v[248:251], v[244:247], v[160:175]
    v_mfma_f32_32x32x16_bf16 v[176:191], v[244:247], v[252:255], v[176:191]
    ds_read_b128 v[244:247], v6 offset:32768
    ds_read_b64_tr_b16 v[248:249], v9 offset:51200
    ds_read_b64_tr_b16 v[250:251], v9 offset:51712
    ds_read_b64_tr_b16 v[252:253], v9 offset:59392
    ds_read_b64_tr_b16 v[254:255], v9 offset:59904
    s_waitcnt lgkmcnt(10)
    v_mfma_f32_32x32x16_bf16 v[160:175], v[224:227], v[220:223], v[160:175]
    v_mfma_f32_32x32x16_bf16 v[176:191], v[220:223], v[228:231], v[176:191]
    ds_read_b128 v[220:223], v7 offset:32768
    ds_read_b64_tr_b16 v[224:225], v9 offset:53248
    ds_read_b64_tr_b16 v[226:227], v9 offset:53760
    ds_read_b64_tr_b16 v[228:229], v9 offset:61440
    ds_read_b64_tr_b16 v[230:231], v9 offset:61952
    s_waitcnt lgkmcnt(10)
    v_mfma_f32_32x32x16_bf16 v[160:175], v[236:239], v[232:235], v[160:175]
    v_mfma_f32_32x32x16_bf16 v[176:191], v[232:235], v[240:243], v[176:191]
    ds_read_b128 v[232:235], v8 offset:32768
    ds_read_b64_tr_b16 v[236:237], v9 offset:55296
    ds_read_b64_tr_b16 v[238:239], v9 offset:55808
    ds_read_b64_tr_b16 v[240:241], v9 offset:63488
    ds_read_b64_tr_b16 v[242:243], v9 offset:64000
    s_waitcnt lgkmcnt(10)
    v_mfma_f32_32x32x16_bf16 v[160:175], v[248:251], v[244:247], v[160:175]
    v_mfma_f32_32x32x16_bf16 v[176:191], v[244:247], v[252:255], v[176:191]
    s_waitcnt lgkmcnt(5)
    v_mfma_f32_32x32x16_bf16 v[160:175], v[224:227], v[220:223], v[160:175]
    v_mfma_f32_32x32x16_bf16 v[176:191], v[220:223], v[228:231], v[176:191]
    s_waitcnt lgkmcnt(0)
    v_mfma_f32_32x32x16_bf16 v[160:175], v[236:239], v[232:235], v[160:175]
    v_mfma_f32_32x32x16_bf16 v[176:191], v[232:235], v[240:243], v[176:191]
    s_branch L_B4_done
L_B4_q:
    ds_read_b128 v[220:223], v5 offset:0
    ds_read_b64_tr_b16 v[224:225], v9 offset:8192
    ds_read_b64_tr_b16 v[226:227], v9 offset:8704
    ds_read_b128 v[228:231], v6 offset:0
    ds_read_b64_tr_b16 v[232:233], v9 offset:10240
    ds_read_b64_tr_b16 v[234:235], v9 offset:10752
    ds_read_b128 v[236:239], v7 offset:0
    ds_read_b64_tr_b16 v[240:241], v9 offset:12288
    ds_read_b64_tr_b16 v[242:243], v9 offset:12800
    ds_read_b128 v[244:247], v8 offset:0
    ds_read_b64_tr_b16 v[248:249], v9 offset:14336
    ds_read_b64_tr_b16 v[250:251], v9 offset:14848
    s_waitcnt lgkmcnt(9)
    v_mfma_f32_32x32x16_bf16 v[160:175], v[224:227], v[220:223], v[160:175]
    ds_read_b128 v[220:223], v5 offset:32768
    ds_read_b64_tr_b16 v[224:225], v9 offset:40960
    ds_read_b64_tr_b16 v[226:227], v9 offset:41472
    s_waitcnt lgkmcnt(9)
    v_mfma_f32_32x32x16_bf16 v[160:175], v[232:235], v[228:231], v[160:175]
    ds_read_b128 v[228:231], v6 offset:32768
    ds_read_b64_tr_b16 v[232:233], v9 offset:43008
    ds_read_b64_tr_b16 v[234:235], v9 offset:43520
    s_waitcnt lgkmcnt(9)
    v_mfma_f32_32x32x16_bf16 v[160:175], v[240:243], v[236:239], v[160:175]
    ds_read_b128 v[236:239], v7 offset:32768
    ds_read_b64_tr_b16 v[240:241], v9 offset:45056
    ds_read_b64_tr_b16 v[242:243], v9 offset:45568
    s_waitcnt lgkmcnt(9)
    v_mfma_f32_32x32x16_bf16 v[160:175], v[248:251], v[244:247], v[160:175]
    ds_read_b128 v[244:247], v8 offset:32768
    ds_read_b64_tr_b16 v[248:249], v9 offset:47104
    ds_read_b64_tr_b16 v[250:251], v9 offset:47616
    s_waitcnt lgkmcnt(9)
    v_mfma_f32_32x32x16_bf16 v[160:175], v[224:227], v[220:223], v[160:175]
    s_waitcnt lgkmcnt(6)
    v_mfma_f32_32x32x16_bf16 v[160:175], v[232:235], v[228:231], v[160:175]
    s_waitcnt lgkmcnt(3)
    v_mfma_f32_32x32x16_bf16 v[160:175], v[240:243], v[236:239], v[160:175]
    s_waitcnt lgkmcnt(0)
    v_mfma_f32_32x32x16_bf16 v[160:175], v[248:251], v[244:247], v[160:175]
L_B4_done:
    s_mov_b64 s[76:77], s[28:29]
    s_mov_b64 s[78:79], s[30:31]
    s_mov_b64 s[80:81], s[32:33]
    s_mov_b64 s[82:83], s[34:35]
    v_mov_b32 v56, v1
    v_mov_b32 v57, v3
    s_add_u32 s74, s61, 0
    s_add_u32 s75, s61, 32768
    s_mov_b32 s84, 768
    s_mov_b32 s85, 1179648
    s_mov_b32 s86, 1180672
    s_mov_b32 s87, 1181696
    s_mov_b32 s88, 896
    s_mov_b32 s89, 1376256
    s_mov_b32 s90, 1377280
    s_mov_b32 s91, 1378304
    s_barrier
    s_branch L_att
L_h2:
    s_waitcnt vmcnt(0)
    s_barrier
    s_mov_b32 s6, 0x3fb8aa3b
    s_mov_b32 s7, s6
    s_cbranch_vccz L_h2p
    s_setprio 2
L_h2p:
    s_cmp_lg_u32 s62, 0
    s_cbranch_scc1 L_B6_q
    ds_read_b128 v[220:223], v5 offset:0
    ds_read_b64_tr_b16 v[224:225], v9 offset:16384
    ds_read_b64_tr_b16 v[226:227], v9 offset:16896
    ds_read_b64_tr_b16 v[228:229], v9 offset:24576
    ds_read_b64_tr_b16 v[230:231], v9 offset:25088
    ds_read_b128 v[232:235], v6 offset:0
    ds_read_b64_tr_b16 v[236:237], v9 offset:18432
    ds_read_b64_tr_b16 v[238:239], v9 offset:18944
    ds_read_b64_tr_b16 v[240:241], v9 offset:26624
    ds_read_b64_tr_b16 v[242:243], v9 offset:27136
    ds_read_b128 v[244:247], v7 offset:0
    ds_read_b64_tr_b16 v[248:249], v9 offset:20480
    ds_read_b64_tr_b16 v[250:251], v9 offset:20992
    ds_read_b64_tr_b16 v[252:253], v9 offset:28672
    ds_read_b64_tr_b16 v[254:255], v9 offset:29184
    s_waitcnt lgkmcnt(10)
    v_mfma_f32_32x32x16_bf16 v[160:175], v[224:227], v[220:223], v[160:175]
    v_mfma_f32_32x32x16_bf16 v[176:191], v[220:223], v[228:231], v[176:191]
    ds_read_b128 v[220:223], v8 offset:0
    ds_read_b64_tr_b16 v[224:225], v9 offset:22528
    ds_read_b64_tr_b16 v[226:227], v9 offset:23040
    ds_read_b64_tr_b16 v[228:229], v9 offset:30720
    ds_read_b64_tr_b16 v[230:231], v9 offset:31232
    s_waitcnt lgkmcnt(10)
    v_mfma_f32_32x32x16_bf16 v[160:175], v[236:239], v[232:235], v[160:175]
    v_mfma_f32_32x32x16_bf16 v[176:191], v[232:235], v[240:243], v[176:191]
    ds_read_b128 v[232:235], v5 offset:32768
    ds_read_b64_tr_b16 v[236:237], v9 offset:49152
    ds_read_b64_tr_b16 v[238:239], v9 offset:49664
    ds_read_b64_tr_b16 v[240:241], v9 offset:57344
    ds_read_b64_tr_b16 v[242:243], v9 offset:57856
    s_waitcnt lgkmcnt(10)
    v_mfma_f32_32x32x16_bf16 v[160:175], v[248:251], v[244:247], v[160:175]
    v_mfma_f32_32x32x16_bf16 v[176:191], v[244:247], v[252:255], v[176:191]
    ds_read_b128 v[244:247], v6 offset:32768
    ds_read_b64_tr_b16 v[248:249], v9 offset:51200
    ds_read_b64_tr_b16 v[250:251], v9 offset:51712
    ds_read_b64_tr_b16 v[252:253], v9 offset:59392
    ds_read_b64_tr_b16 v[254:255], v9 offset:59904
    s_waitcnt lgkmcnt(10)
    v_mfma_f32_32x32x16_bf16 v[160:175], v[224:227], v[220:223], v[160:175]
    v_mfma_f32_32x32x16_bf16 v[176:191], v[220:223], v[228:231], v[176:191]
    ds_read_b128 v[220:223], v7 offset:32768
    ds_read_b64_tr_b16 v[224:225], v9 offset:53248
    ds_read_b64_tr_b16 v[226:227], v9 offset:53760
    ds_read_b64_tr_b16 v[228:229], v9 offset:61440
    ds_read_b64_tr_b16 v[230:231], v9 offset:61952
    s_waitcnt lgkmcnt(10)
    v_mfma_f32_32x32x16_bf16 v[160:175], v[236:239], v[232:235], v[160:175]
    v_mfma_f32_32x32x16_bf16 v[176:191], v[232:235], v[240:243], v[176:191]
    ds_read_b128 v[232:235], v8 offset:32768
    ds_read_b64_tr_b16 v[236:237], v9 offset:55296
    ds_read_b64_tr_b16 v[238:239], v9 offset:55808
    ds_read_b64_tr_b16 v[240:241], v9 offset:63488
    ds_read_b64_tr_b16 v[242:243], v9 offset:64000
    s_waitcnt lgkmcnt(10)
    v_mfma_f32_32x32x16_bf16 v[160:175], v[248:251], v[244:247], v[160:175]
    v_mfma_f32_32x32x16_bf16 v[176:191], v[244:247], v[252:255], v[176:191]
    s_waitcnt lgkmcnt(5)
    v_mfma_f32_32x32x16_bf16 v[160:175], v[224:227], v[220:223], v[160:175]
    v_mfma_f32_32x32x16_bf16 v[176:191], v[220:223], v[228:231], v[176:191]
    s_waitcnt lgkmcnt(0)
    v_mfma_f32_32x32x16_bf16 v[160:175], v[236:239], v[232:235], v[160:175]
    v_mfma_f32_32x32x16_bf16 v[176:191], v[232:235], v[240:243], v[176:191]
    v_lshlrev_b32 v10, 4, v20
    v_sub_u32 v10, v21, v10
    v_and_b32 v11, 1, v10
    v_lshlrev_b32 v11, 4, v11
    v_mov_b32 v12, 0x3f80
    v_lshlrev_b32 v11, v11, v12
    v_ashrrev_i32 v10, 1, v10
    v_cmp_eq_u32 vcc, 0, v10
    v_cmp_eq_u32 s[4:5], 1, v10
    s_nop 0
    v_cndmask_b32 v192, 0, v11, vcc
    v_cndmask_b32 v193, 0, v11, s[4:5]
    v_cvt_pk_bf16_f32 v40, v160, v161
    v_cvt_pk_bf16_f32 v41, v162, v163
    v_cvt_pk_bf16_f32 v42, v164, v165
    v_cvt_pk_bf16_f32 v43, v166, v167
    v_cvt_pk_bf16_f32 v44, v168, v169
    v_cvt_pk_bf16_f32 v45, v170, v171
    v_cvt_pk_bf16_f32 v46, v172, v173
    v_cvt_pk_bf16_f32 v47, v174, v175
    v_cvt_pk_bf16_f32 v48, v176, v177
    v_cvt_pk_bf16_f32 v49, v178, v179
    v_cvt_pk_bf16_f32 v50, v180, v181
    v_cvt_pk_bf16_f32 v51, v182, v183
    v_cvt_pk_bf16_f32 v52, v184, v185
    v_cvt_pk_bf16_f32 v53, v186, v187
    v_cvt_pk_bf16_f32 v54, v188, v189
    v_cvt_pk_bf16_f32 v55, v190, v191
    v_mfma_f32_32x32x16_bf16 v[220:235], v[24:27], v[40:43], 0
    v_mfma_f32_32x32x16_bf16 v[236:251], v[28:31], v[44:47], 0
    v_cmp_eq_u32 vcc, 2, v10
    v_cmp_eq_u32 s[4:5], 3, v10
    s_nop 0
    v_cndmask_b32 v194, 0, v11, vcc
    v_cndmask_b32 v195, 0, v11, s[4:5]
    v_cmp_eq_u32 vcc, 4, v10
    v_cmp_eq_u32 s[4:5], 5, v10
    s_nop 0
    v_cndmask_b32 v196, 0, v11, vcc
    v_cndmask_b32 v197, 0, v11, s[4:5]
    v_cmp_eq_u32 vcc, 6, v10
    v_cmp_eq_u32 s[4:5], 7, v10
    s_nop 0
    v_cndmask_b32 v198, 0, v11, vcc
    v_cndmask_b32 v199, 0, v11, s[4:5]
    v_max3_f32 v10, v220, v221, v222
    v_max3_f32 v10, v10, v223, v224
    v_max3_f32 v10, v10, v225, v226
    v_max3_f32 v10, v10, v227, v228
    v_max3_f32 v10, v10, v229, v230
    v_max3_f32 v10, v10, v231, v232
    v_max3_f32 v10, v10, v233, v234
    v_max_f32 v10, v10, v235
    v_pk_add_f32 v[220:221], v[220:221], v[10:11] op_sel_hi:[1,0] neg_lo:[0,1] neg_hi:[0,1]
    v_pk_add_f32 v[222:223], v[222:223], v[10:11] op_sel_hi:[1,0] neg_lo:[0,1] neg_hi:[0,1]
    v_pk_add_f32 v[224:225], v[224:225], v[10:11] op_sel_hi:[1,0] neg_lo:[0,1] neg_hi:[0,1]
    v_pk_add_f32 v[226:227], v[226:227], v[10:11] op_sel_hi:[1,0] neg_lo:[0,1] neg_hi:[0,1]
    v_pk_add_f32 v[228:229], v[228:229], v[10:11] op_sel_hi:[1,0] neg_lo:[0,1] neg_hi:[0,1]
    v_pk_add_f32 v[230:231], v[230:231], v[10:11] op_sel_hi:[1,0] neg_lo:[0,1] neg_hi:[0,1]
    v_pk_add_f32 v[232:233], v[232:233], v[10:11] op_sel_hi:[1,0] neg_lo:[0,1] neg_hi:[0,1]
    v_pk_add_f32 v[234:235], v[234:235], v[10:11] op_sel_hi:[1,0] neg_lo:[0,1] neg_hi:[0,1]
    v_pk_mul_f32 v[220:221], v[220:221], s[6:7]
    v_pk_mul_f32 v[222:223], v[222:223], s[6:7]
    v_pk_mul_f32 v[224:225], v[224:225], s[6:7]
    v_pk_mul_f32 v[226:227], v[226:227], s[6:7]
    v_pk_mul_f32 v[228:229], v[228:229], s[6:7]
    v_pk_mul_f32 v[230:231], v[230:231], s[6:7]
    v_pk_mul_f32 v[232:233], v[232:233], s[6:7]
    v_pk_mul_f32 v[234:235], v[234:235], s[6:7]
    v_exp_f32 v220, v220
    v_exp_f32 v221, v221
    v_exp_f32 v222, v222
    v_exp_f32 v223, v223
    v_exp_f32 v224, v224
    v_exp_f32 v225, v225
    v_exp_f32 v226, v226
    v_exp_f32 v227, v227
    v_exp_f32 v228, v228
    v_exp_f32 v229, v229
    v_exp_f32 v230, v230
    v_exp_f32 v231, v231
    v_exp_f32 v232, v232
    v_exp_f32 v233, v233
    v_exp_f32 v234, v234
    v_exp_f32 v235, v235
    v_pk_add_f32 v[10:11], v[220:221], v[222:223]
    v_pk_add_f32 v[10:11], v[10:11], v[224:225]
    v_pk_add_f32 v[10:11], v[10:11], v[226:227]
    v_pk_add_f32 v[10:11], v[10:11], v[228:229]
    v_pk_add_f32 v[10:11], v[10:11], v[230:231]
    v_pk_add_f32 v[10:11], v[10:11], v[232:233]
    v_pk_add_f32 v[10:11], v[10:11], v[234:235]
    v_add_f32 v10, v10, v11
    v_rcp_f32 v10, v10
    s_nop 0
    v_pk_mul_f32 v[220:221], v[220:221], v[10:11] op_sel_hi:[1,0]
    v_pk_mul_f32 v[222:223], v[222:223], v[10:11] op_sel_hi:[1,0]
    v_pk_mul_f32 v[224:225], v[224:225], v[10:11] op_sel_hi:[1,0]
    v_pk_mul_f32 v[226:227], v[226:227], v[10:11] op_sel_hi:[1,0]
    v_pk_mul_f32 v[228:229], v[228:229], v[10:11] op_sel_hi:[1,0]
    v_pk_mul_f32 v[230:231], v[230:231], v[10:11] op_sel_hi:[1,0]
    v_pk_mul_f32 v[232:233], v[232:233], v[10:11] op_sel_hi:[1,0]
    v_pk_mul_f32 v[234:235], v[234:235], v[10:11] op_sel_hi:[1,0]
    v_cvt_pk_bf16_f32 v80, v220, v221
    v_cvt_pk_bf16_f32 v81, v222, v223
    v_cvt_pk_bf16_f32 v82, v224, v225
    v_cvt_pk_bf16_f32 v83, v226, v227
    v_cvt_pk_bf16_f32 v84, v228, v229
    v_cvt_pk_bf16_f32 v85, v230, v231
    v_cvt_pk_bf16_f32 v86, v232, v233
    v_cvt_pk_bf16_f32 v87, v234, v235
    s_nop 1
    v_mfma_f32_32x32x16_bf16 v[220:235], v[80:83], v[192:195], 0
    v_mfma_f32_32x32x16_bf16 v[220:235], v[84:87], v[196:199], v[220:235]
    v_cmp_gt_u32 vcc, 16, v21
    v_mov_b32 v11, 0x3f803f80
    s_nop 0
    v_cndmask_b32 v88, v11, v48, vcc
    v_cndmask_b32 v89, v11, v49, vcc
    v_cndmask_b32 v90, v11, v50, vcc
    v_cndmask_b32 v91, v11, v51, vcc
    v_cndmask_b32 v92, v11, v52, vcc
    v_cndmask_b32 v93, v11, v53, vcc
    v_cndmask_b32 v94, v11, v54, vcc
    v_cndmask_b32 v95, v11, v55, vcc
    s_nop 2
    v_cvt_pk_bf16_f32 v80, v220, v221
    v_cvt_pk_bf16_f32 v81, v222, v223
    v_cvt_pk_bf16_f32 v82, v224, v225
    v_cvt_pk_bf16_f32 v83, v226, v227
    v_cvt_pk_bf16_f32 v84, v228, v229
    v_cvt_pk_bf16_f32 v85, v230, v231
    v_cvt_pk_bf16_f32 v86, v232, v233
    v_cvt_pk_bf16_f32 v87, v234, v235
    s_nop 1
    v_mfma_f32_32x32x16_bf16 v[160:175], v[88:91], v[80:83], 0
    v_mfma_f32_32x32x16_bf16 v[160:175], v[92:95], v[84:87], v[160:175]
    s_nop 1
    v_max3_f32 v10, v236, v237, v238
    v_max3_f32 v10, v10, v239, v240
    v_max3_f32 v10, v10, v241, v242
    v_max3_f32 v10, v10, v243, v244
    v_max3_f32 v10, v10, v245, v246
    v_max3_f32 v10, v10, v247, v248
    v_max3_f32 v10, v10, v249, v250
    v_max_f32 v10, v10, v251
    v_pk_add_f32 v[236:237], v[236:237], v[10:11] op_sel_hi:[1,0] neg_lo:[0,1] neg_hi:[0,1]
    v_pk_add_f32 v[238:239], v[238:239], v[10:11] op_sel_hi:[1,0] neg_lo:[0,1] neg_hi:[0,1]
    v_pk_add_f32 v[240:241], v[240:241], v[10:11] op_sel_hi:[1,0] neg_lo:[0,1] neg_hi:[0,1]
    v_pk_add_f32 v[242:243], v[242:243], v[10:11] op_sel_hi:[1,0] neg_lo:[0,1] neg_hi:[0,1]
    v_pk_add_f32 v[244:245], v[244:245], v[10:11] op_sel_hi:[1,0] neg_lo:[0,1] neg_hi:[0,1]
    v_pk_add_f32 v[246:247], v[246:247], v[10:11] op_sel_hi:[1,0] neg_lo:[0,1] neg_hi:[0,1]
    v_pk_add_f32 v[248:249], v[248:249], v[10:11] op_sel_hi:[1,0] neg_lo:[0,1] neg_hi:[0,1]
    v_pk_add_f32 v[250:251], v[250:251], v[10:11] op_sel_hi:[1,0] neg_lo:[0,1] neg_hi:[0,1]
    v_pk_mul_f32 v[236:237], v[236:237], s[6:7]
    v_pk_mul_f32 v[238:239], v[238:239], s[6:7]
    v_pk_mul_f32 v[240:241], v[240:241], s[6:7]
    v_pk_mul_f32 v[242:243], v[242:243], s[6:7]
    v_pk_mul_f32 v[244:245], v[244:245], s[6:7]
    v_pk_mul_f32 v[246:247], v[246:247], s[6:7]
    v_pk_mul_f32 v[248:249], v[248:249], s[6:7]
    v_pk_mul_f32 v[250:251], v[250:251], s[6:7]
    v_exp_f32 v236, v236
    v_exp_f32 v237, v237
    v_exp_f32 v238, v238
    v_exp_f32 v239, v239
    v_exp_f32 v240, v240
    v_exp_f32 v241, v241
    v_exp_f32 v242, v242
    v_exp_f32 v243, v243
    v_exp_f32 v244, v244
    v_exp_f32 v245, v245
    v_exp_f32 v246, v246
    v_exp_f32 v247, v247
    v_exp_f32 v248, v248
    v_exp_f32 v249, v249
    v_exp_f32 v250, v250
    v_exp_f32 v251, v251
    v_pk_add_f32 v[10:11], v[236:237], v[238:239]
    v_pk_add_f32 v[10:11], v[10:11], v[240:241]
    v_pk_add_f32 v[10:11], v[10:11], v[242:243]
    v_pk_add_f32 v[10:11], v[10:11], v[244:245]
    v_pk_add_f32 v[10:11], v[10:11], v[246:247]
    v_pk_add_f32 v[10:11], v[10:11], v[248:249]
    v_pk_add_f32 v[10:11], v[10:11], v[250:251]
    v_add_f32 v10, v10, v11
    v_rcp_f32 v10, v10
    s_nop 0
    v_pk_mul_f32 v[236:237], v[236:237], v[10:11] op_sel_hi:[1,0]
    v_pk_mul_f32 v[238:239], v[238:239], v[10:11] op_sel_hi:[1,0]
    v_pk_mul_f32 v[240:241], v[240:241], v[10:11] op_sel_hi:[1,0]
    v_pk_mul_f32 v[242:243], v[242:243], v[10:11] op_sel_hi:[1,0]
    v_pk_mul_f32 v[244:245], v[244:245], v[10:11] op_sel_hi:[1,0]
    v_pk_mul_f32 v[246:247], v[246:247], v[10:11] op_sel_hi:[1,0]
    v_pk_mul_f32 v[248:249], v[248:249], v[10:11] op_sel_hi:[1,0]
    v_pk_mul_f32 v[250:251], v[250:251], v[10:11] op_sel_hi:[1,0]
    v_cvt_pk_bf16_f32 v80, v236, v237
    v_cvt_pk_bf16_f32 v81, v238, v239
    v_cvt_pk_bf16_f32 v82, v240, v241
    v_cvt_pk_bf16_f32 v83, v242, v243
    v_cvt_pk_bf16_f32 v84, v244, v245
    v_cvt_pk_bf16_f32 v85, v246, v247
    v_cvt_pk_bf16_f32 v86, v248, v249
    v_cvt_pk_bf16_f32 v87, v250, v251
    s_nop 1
    v_mfma_f32_32x32x16_bf16 v[236:251], v[80:83], v[192:195], 0
    v_mfma_f32_32x32x16_bf16 v[236:251], v[84:87], v[196:199], v[236:251]
    v_cmp_le_u32 vcc, 16, v21
    v_mov_b32 v11, 0x3f803f80
    s_nop 0
    v_cndmask_b32 v88, v11, v48, vcc
    v_cndmask_b32 v89, v11, v49, vcc
    v_cndmask_b32 v90, v11, v50, vcc
    v_cndmask_b32 v91, v11, v51, vcc
    v_cndmask_b32 v92, v11, v52, vcc
    v_cndmask_b32 v93, v11, v53, vcc
    v_cndmask_b32 v94, v11, v54, vcc
    v_cndmask_b32 v95, v11, v55, vcc
    s_nop 2
    v_cvt_pk_bf16_f32 v80, v236, v237
    v_cvt_pk_bf16_f32 v81, v238, v239
    v_cvt_pk_bf16_f32 v82, v240, v241
    v_cvt_pk_bf16_f32 v83, v242, v243
    v_cvt_pk_bf16_f32 v84, v244, v245
    v_cvt_pk_bf16_f32 v85, v246, v247
    v_cvt_pk_bf16_f32 v86, v248, v249
    v_cvt_pk_bf16_f32 v87, v250, v251
    s_nop 1
    v_mfma_f32_32x32x16_bf16 v[176:191], v[88:91], v[80:83], 0
    v_mfma_f32_32x32x16_bf16 v[176:191], v[92:95], v[84:87], v[176:191]
    s_nop 1
    s_lshl_b32 s3, s58, 2
    s_add_u32 s3, s3, s56
    s_lshl_b32 s3, s3, 1
    s_and_b32 s4, s57, 1
    s_add_u32 s3, s3, s4
    s_lshl_b32 s3, s3, 12
    s_add_u32 s3, s3, 6291456
    v_lshlrev_b32 v10, 2, v21
    v_lshl_add_u32 v10, v20, 9, v10
    v_mul_u32_u24 v11, 3, v4
    v_add_u32 v11, 98304, v11
    v_xor_b32 v12, 0x400, v4
    v_mul_u32_u24 v12, 3, v12
    v_add_u32 v12, 98304, v12
    s_cmp_eq_u32 s59, 0
    s_cbranch_scc1 L_kvns
    v_swap_b32 v160, v184
    v_swap_b32 v161, v185
    v_swap_b32 v162, v186
    v_swap_b32 v163, v187
    v_swap_b32 v164, v188
    v_swap_b32 v165, v189
    v_swap_b32 v166, v190
    v_swap_b32 v167, v191
    v_swap_b32 v168, v176
L_kvns:
    ds_write_b128 v12, v[184:187]
    ds_write_b128 v12, v[188:191] offset:16
    ds_write_b32 v12, v176 offset:32
    s_waitcnt lgkmcnt(0)
    s_barrier
    ds_read_b128 v[184:187], v11 offset:0
    ds_read_b128 v[188:191], v11 offset:16
    ds_read_b32 v176, v11 offset:32
    s_waitcnt lgkmcnt(0)
    v_add_f32 v160, v160, v184
    v_add_f32 v161, v161, v185
    v_add_f32 v162, v162, v186
    v_add_f32 v163, v163, v187
    v_add_f32 v164, v164, v188
    v_add_f32 v165, v165, v189
    v_add_f32 v166, v166, v190
    v_add_f32 v167, v167, v191
    v_add_f32 v168, v168, v176
    buffer_atomic_add_f32 v160, v10, s[52:55], s3 offen offset:0
    buffer_atomic_add_f32 v161, v10, s[52:55], s3 offen offset:128
    buffer_atomic_add_f32 v162, v10, s[52:55], s3 offen offset:256
    buffer_atomic_add_f32 v163, v10, s[52:55], s3 offen offset:384
    buffer_atomic_add_f32 v164, v10, s[52:55], s3 offen offset:1024
    buffer_atomic_add_f32 v165, v10, s[52:55], s3 offen offset:1152
    buffer_atomic_add_f32 v166, v10, s[52:55], s3 offen offset:1280
    buffer_atomic_add_f32 v167, v10, s[52:55], s3 offen offset:1408
    buffer_atomic_add_f32 v168, v10, s[52:55], s3 offen offset:2048
    s_branch L_B6_done
L_B6_q:
    ds_read_b128 v[220:223], v5 offset:0
    ds_read_b64_tr_b16 v[224:225], v9 offset:8192
    ds_read_b64_tr_b16 v[226:227], v9 offset:8704
    ds_read_b128 v[228:231], v6 offset:0
    ds_read_b64_tr_b16 v[232:233], v9 offset:10240
    ds_read_b64_tr_b16 v[234:235], v9 offset:10752
    ds_read_b128 v[236:239], v7 offset:0
    ds_read_b64_tr_b16 v[240:241], v9 offset:12288
    ds_read_b64_tr_b16 v[242:243], v9 offset:12800
    ds_read_b128 v[244:247], v8 offset:0
    ds_read_b64_tr_b16 v[248:249], v9 offset:14336
    ds_read_b64_tr_b16 v[250:251], v9 offset:14848
    s_waitcnt lgkmcnt(9)
    v_mfma_f32_32x32x16_bf16 v[160:175], v[224:227], v[220:223], v[160:175]
    ds_read_b128 v[220:223], v5 offset:32768
    ds_read_b64_tr_b16 v[224:225], v9 offset:40960
    ds_read_b64_tr_b16 v[226:227], v9 offset:41472
    s_waitcnt lgkmcnt(9)
    v_mfma_f32_32x32x16_bf16 v[160:175], v[232:235], v[228:231], v[160:175]
    ds_read_b128 v[228:231], v6 offset:32768
    ds_read_b64_tr_b16 v[232:233], v9 offset:43008
    ds_read_b64_tr_b16 v[234:235], v9 offset:43520
    s_waitcnt lgkmcnt(9)
    v_mfma_f32_32x32x16_bf16 v[160:175], v[240:243], v[236:239], v[160:175]
    ds_read_b128 v[236:239], v7 offset:32768
    ds_read_b64_tr_b16 v[240:241], v9 offset:45056
    ds_read_b64_tr_b16 v[242:243], v9 offset:45568
    s_waitcnt lgkmcnt(9)
    v_mfma_f32_32x32x16_bf16 v[160:175], v[248:251], v[244:247], v[160:175]
    ds_read_b128 v[244:247], v8 offset:32768
    ds_read_b64_tr_b16 v[248:249], v9 offset:47104
    ds_read_b64_tr_b16 v[250:251], v9 offset:47616
    s_waitcnt lgkmcnt(9)
    v_mfma_f32_32x32x16_bf16 v[160:175], v[224:227], v[220:223], v[160:175]
    s_waitcnt lgkmcnt(6)
    v_mfma_f32_32x32x16_bf16 v[160:175], v[232:235], v[228:231], v[160:175]
    s_waitcnt lgkmcnt(3)
    v_mfma_f32_32x32x16_bf16 v[160:175], v[240:243], v[236:239], v[160:175]
    s_waitcnt lgkmcnt(0)
    v_mfma_f32_32x32x16_bf16 v[160:175], v[248:251], v[244:247], v[160:175]
    s_nop 11
    v_cvt_pk_bf16_f32 v176, v160, v161
    v_cvt_pk_bf16_f32 v177, v162, v163
    v_cvt_pk_bf16_f32 v178, v164, v165
    v_cvt_pk_bf16_f32 v179, v166, v167
    v_cvt_pk_bf16_f32 v180, v168, v169
    v_cvt_pk_bf16_f32 v181, v170, v171
    v_cvt_pk_bf16_f32 v182, v172, v173
    v_cvt_pk_bf16_f32 v183, v174, v175
    s_nop 1
    v_mfma_f32_32x32x16_bf16 v[220:235], v[24:27], v[176:179], 0
    v_mfma_f32_32x32x16_bf16 v[236:251], v[28:31], v[180:183], 0
    s_nop 11
    v_max3_f32 v10, v220, v221, v222
    v_max3_f32 v10, v10, v223, v224
    v_max3_f32 v10, v10, v225, v226
    v_max3_f32 v10, v10, v227, v228
    v_max3_f32 v10, v10, v229, v230
    v_max3_f32 v10, v10, v231, v232
    v_max3_f32 v10, v10, v233, v234
    v_max_f32 v10, v10, v235
    v_pk_add_f32 v[220:221], v[220:221], v[10:11] op_sel_hi:[1,0] neg_lo:[0,1] neg_hi:[0,1]
    v_pk_add_f32 v[222:223], v[222:223], v[10:11] op_sel_hi:[1,0] neg_lo:[0,1] neg_hi:[0,1]
    v_pk_add_f32 v[224:225], v[224:225], v[10:11] op_sel_hi:[1,0] neg_lo:[0,1] neg_hi:[0,1]
    v_pk_add_f32 v[226:227], v[226:227], v[10:11] op_sel_hi:[1,0] neg_lo:[0,1] neg_hi:[0,1]
    v_pk_add_f32 v[228:229], v[228:229], v[10:11] op_sel_hi:[1,0] neg_lo:[0,1] neg_hi:[0,1]
    v_pk_add_f32 v[230:231], v[230:231], v[10:11] op_sel_hi:[1,0] neg_lo:[0,1] neg_hi:[0,1]
    v_pk_add_f32 v[232:233], v[232:233], v[10:11] op_sel_hi:[1,0] neg_lo:[0,1] neg_hi:[0,1]
    v_pk_add_f32 v[234:235], v[234:235], v[10:11] op_sel_hi:[1,0] neg_lo:[0,1] neg_hi:[0,1]
    v_pk_mul_f32 v[220:221], v[220:221], s[6:7]
    v_pk_mul_f32 v[222:223], v[222:223], s[6:7]
    v_pk_mul_f32 v[224:225], v[224:225], s[6:7]
    v_pk_mul_f32 v[226:227], v[226:227], s[6:7]
    v_pk_mul_f32 v[228:229], v[228:229], s[6:7]
    v_pk_mul_f32 v[230:231], v[230:231], s[6:7]
    v_pk_mul_f32 v[232:233], v[232:233], s[6:7]
    v_pk_mul_f32 v[234:235], v[234:235], s[6:7]
    v_exp_f32 v220, v220
    v_exp_f32 v221, v221
    v_exp_f32 v222, v222
    v_exp_f32 v223, v223
    v_exp_f32 v224, v224
    v_exp_f32 v225, v225
    v_exp_f32 v226, v226
    v_exp_f32 v227, v227
    v_exp_f32 v228, v228
    v_exp_f32 v229, v229
    v_exp_f32 v230, v230
    v_exp_f32 v231, v231
    v_exp_f32 v232, v232
    v_exp_f32 v233, v233
    v_exp_f32 v234, v234
    v_exp_f32 v235, v235
    v_pk_add_f32 v[10:11], v[220:221], v[222:223]
    v_pk_add_f32 v[10:11], v[10:11], v[224:225]
    v_pk_add_f32 v[10:11], v[10:11], v[226:227]
    v_pk_add_f32 v[10:11], v[10:11], v[228:229]
    v_pk_add_f32 v[10:11], v[10:11], v[230:231]
    v_pk_add_f32 v[10:11], v[10:11], v[232:233]
    v_pk_add_f32 v[10:11], v[10:11], v[234:235]
    v_add_f32 v10, v10, v11
    v_rcp_f32 v10, v10
    s_nop 0
    v_pk_mul_f32 v[220:221], v[220:221], v[10:11] op_sel_hi:[1,0]
    v_pk_mul_f32 v[222:223], v[222:223], v[10:11] op_sel_hi:[1,0]
    v_pk_mul_f32 v[224:225], v[224:225], v[10:11] op_sel_hi:[1,0]
    v_pk_mul_f32 v[226:227], v[226:227], v[10:11] op_sel_hi:[1,0]
    v_pk_mul_f32 v[228:229], v[228:229], v[10:11] op_sel_hi:[1,0]
    v_pk_mul_f32 v[230:231], v[230:231], v[10:11] op_sel_hi:[1,0]
    v_pk_mul_f32 v[232:233], v[232:233], v[10:11] op_sel_hi:[1,0]
    v_pk_mul_f32 v[234:235], v[234:235], v[10:11] op_sel_hi:[1,0]
    v_cvt_pk_bf16_f32 v40, v220, v221
    v_cvt_pk_bf16_f32 v41, v222, v223
    v_cvt_pk_bf16_f32 v42, v224, v225
    v_cvt_pk_bf16_f32 v43, v226, v227
    v_cvt_pk_bf16_f32 v44, v228, v229
    v_cvt_pk_bf16_f32 v45, v230, v231
    v_cvt_pk_bf16_f32 v46, v232, v233
    v_cvt_pk_bf16_f32 v47, v234, v235
    v_max3_f32 v10, v236, v237, v238
    v_max3_f32 v10, v10, v239, v240
    v_max3_f32 v10, v10, v241, v242
    v_max3_f32 v10, v10, v243, v244
    v_max3_f32 v10, v10, v245, v246
    v_max3_f32 v10, v10, v247, v248
    v_max3_f32 v10, v10, v249, v250
    v_max_f32 v10, v10, v251
    v_pk_add_f32 v[236:237], v[236:237], v[10:11] op_sel_hi:[1,0] neg_lo:[0,1] neg_hi:[0,1]
    v_pk_add_f32 v[238:239], v[238:239], v[10:11] op_sel_hi:[1,0] neg_lo:[0,1] neg_hi:[0,1]
    v_pk_add_f32 v[240:241], v[240:241], v[10:11] op_sel_hi:[1,0] neg_lo:[0,1] neg_hi:[0,1]
    v_pk_add_f32 v[242:243], v[242:243], v[10:11] op_sel_hi:[1,0] neg_lo:[0,1] neg_hi:[0,1]
    v_pk_add_f32 v[244:245], v[244:245], v[10:11] op_sel_hi:[1,0] neg_lo:[0,1] neg_hi:[0,1]
    v_pk_add_f32 v[246:247], v[246:247], v[10:11] op_sel_hi:[1,0] neg_lo:[0,1] neg_hi:[0,1]
    v_pk_add_f32 v[248:249], v[248:249], v[10:11] op_sel_hi:[1,0] neg_lo:[0,1] neg_hi:[0,1]
    v_pk_add_f32 v[250:251], v[250:251], v[10:11] op_sel_hi:[1,0] neg_lo:[0,1] neg_hi:[0,1]
    v_pk_mul_f32 v[236:237], v[236:237], s[6:7]
    v_pk_mul_f32 v[238:239], v[238:239], s[6:7]
    v_pk_mul_f32 v[240:241], v[240:241], s[6:7]
    v_pk_mul_f32 v[242:243], v[242:243], s[6:7]
    v_pk_mul_f32 v[244:245], v[244:245], s[6:7]
    v_pk_mul_f32 v[246:247], v[246:247], s[6:7]
    v_pk_mul_f32 v[248:249], v[248:249], s[6:7]
    v_pk_mul_f32 v[250:251], v[250:251], s[6:7]
    v_exp_f32 v236, v236
    v_exp_f32 v237, v237
    v_exp_f32 v238, v238
    v_exp_f32 v239, v239
    v_exp_f32 v240, v240
    v_exp_f32 v241, v241
    v_exp_f32 v242, v242
    v_exp_f32 v243, v243
    v_exp_f32 v244, v244
    v_exp_f32 v245, v245
    v_exp_f32 v246, v246
    v_exp_f32 v247, v247
    v_exp_f32 v248, v248
    v_exp_f32 v249, v249
    v_exp_f32 v250, v250
    v_exp_f32 v251, v251
    v_pk_add_f32 v[10:11], v[236:237], v[238:239]
    v_pk_add_f32 v[10:11], v[10:11], v[240:241]
    v_pk_add_f32 v[10:11], v[10:11], v[242:243]
    v_pk_add_f32 v[10:11], v[10:11], v[244:245]
    v_pk_add_f32 v[10:11], v[10:11], v[246:247]
    v_pk_add_f32 v[10:11], v[10:11], v[248:249]
    v_pk_add_f32 v[10:11], v[10:11], v[250:251]
    v_add_f32 v10, v10, v11
    v_rcp_f32 v10, v10
    s_nop 0
    v_pk_mul_f32 v[236:237], v[236:237], v[10:11] op_sel_hi:[1,0]
    v_pk_mul_f32 v[238:239], v[238:239], v[10:11] op_sel_hi:[1,0]
    v_pk_mul_f32 v[240:241], v[240:241], v[10:11] op_sel_hi:[1,0]
    v_pk_mul_f32 v[242:243], v[242:243], v[10:11] op_sel_hi:[1,0]
    v_pk_mul_f32 v[244:245], v[244:245], v[10:11] op_sel_hi:[1,0]
    v_pk_mul_f32 v[246:247], v[246:247], v[10:11] op_sel_hi:[1,0]
    v_pk_mul_f32 v[248:249], v[248:249], v[10:11] op_sel_hi:[1,0]
    v_pk_mul_f32 v[250:251], v[250:251], v[10:11] op_sel_hi:[1,0]
    v_cvt_pk_bf16_f32 v48, v236, v237
    v_cvt_pk_bf16_f32 v49, v238, v239
    v_cvt_pk_bf16_f32 v50, v240, v241
    v_cvt_pk_bf16_f32 v51, v242, v243
    v_cvt_pk_bf16_f32 v52, v244, v245
    v_cvt_pk_bf16_f32 v53, v246, v247
    v_cvt_pk_bf16_f32 v54, v248, v249
    v_cvt_pk_bf16_f32 v55, v250, v251
    s_barrier
L_B6_done:
    s_branch L_att
L_hm:
    s_cmp_eq_u32 s66, 7
    s_cbranch_scc1 L_hm7
    s_cmp_eq_u32 s66, 5
    s_cbranch_scc1 L_hm5
    s_cmp_eq_u32 s66, 4
    s_cbranch_scc1 L_hm4
    s_cmp_lg_u32 s62, 0
    s_cbranch_scc1 L_mid
    s_waitcnt vmcnt(0)
    s_lshl_b32 s3, s58, 8
    s_add_u32 s3, s3, 282624
    v_mov_b32 v10, 1
    s_mov_b64 exec, 1
    buffer_atomic_add v10, off, s[52:55], s3
    s_mov_b64 exec, -1
    s_branch L_mid
L_h4:
    s_mov_b64 s[76:77], s[52:53]
    s_mov_b64 s[78:79], s[54:55]
    s_mov_b64 s[80:81], s[52:53]
    s_mov_b64 s[82:83], s[54:55]
    v_mov_b32 v56, v4
    v_mov_b32 v57, v4
    s_add_u32 s74, s61, 98304
    s_add_u32 s75, s61, 98304
    s_mov_b32 s84, 49152
    s_mov_b32 s85, 114688
    s_mov_b32 s86, 57344
    s_mov_b32 s87, 122880
    s_branch L_att
L_hm4:
    s_cmp_lg_u32 s56, 7
    s_cbranch_scc1 L_mid
    s_lshl_b32 s3, s58, 8
    s_add_u32 s3, s3, 282624
    v_mov_b32 v18, 0
    buffer_load_dword v19, v18, s[52:55], s3 offen sc1
    s_branch L_mid
L_h5:
    s_mov_b64 s[76:77], s[40:41]
    s_mov_b64 s[78:79], s[42:43]
    s_mov_b64 s[80:81], s[40:41]
    s_mov_b64 s[82:83], s[42:43]
    v_mov_b32 v56, v2
    v_mov_b32 v57, v2
    s_add_u32 s74, s61, 0
    s_add_u32 s75, s61, 32768
    s_mov_b32 s84, 0
    s_mov_b32 s85, 65536
    s_mov_b32 s86, 131072
    s_mov_b32 s87, 196608
    s_mov_b32 s88, 262144
    s_mov_b32 s89, 327680
    s_mov_b32 s90, 393216
    s_mov_b32 s91, 458752
    s_cmp_lg_u32 s56, 7
    s_cbranch_scc1 L_pd_f2
    s_movk_i32 s4, 128
    s_mov_b32 s65, 0x40000
    s_branch L_pc_f2
L_p_f2:
    buffer_load_dword v19, v18, s[52:55], s3 offen sc1
L_pc_f2:
    s_waitcnt vmcnt(0)
    v_cmp_ne_u32 vcc, s4, v19
    s_sub_u32 s65, s65, 1
    s_cbranch_scc1 L_pd_f2
    s_cmp_eq_u64 vcc, 0
    s_cbranch_scc1 L_pd_f2
    s_sleep 8
    s_branch L_p_f2
L_pd_f2:
    s_lshl_b32 s3, s58, 15
    s_lshl_b32 s4, s56, 12
    s_add_u32 s3, s3, s4
    s_add_u32 s3, s3, 6291456
    s_add_u32 m0, s4, 131072
    v_lshrrev_b32 v10, 3, v0
    v_xor_b32 v10, v0, v10
    v_lshlrev_b32 v10, 4, v10
    s_waitcnt vmcnt(0)
    s_barrier
    buffer_load_dwordx4 v10, s[52:55], s3 offen offset:0 sc1 lds
    buffer_load_dwordx4 v10, s[52:55], s3 offen offset:1024 sc1 lds
    buffer_load_dwordx4 v10, s[52:55], s3 offen offset:2048 sc1 lds
    s_branch L_att
L_hm5:
    s_waitcnt vmcnt(8)
    s_barrier
    s_cmp_eq_u32 s62, 0
    s_cbranch_scc1 L_mid
    v_min_u32 v10, 16, v21
    v_and_b32 v11, 7, v10
    v_lshlrev_b32 v12, 2, v20
    v_xor_b32 v11, v11, v12
    s_lshl_b32 s3, s60, 14
    s_add_u32 s3, s3, 131072
    v_lshl_add_u32 v10, v10, 7, s3
    v_lshl_add_u32 v12, v11, 4, v10
    v_xor_b32 v13, 16, v12
    v_xor_b32 v14, 32, v12
    v_xor_b32 v15, 48, v12
    ds_read_b128 v[220:223], v12 offset:0
    ds_read_b128 v[224:227], v13 offset:0
    ds_read_b128 v[228:231], v14 offset:0
    ds_read_b128 v[232:235], v15 offset:0
    ds_read_b128 v[160:163], v12 offset:4096
    ds_read_b128 v[164:167], v13 offset:4096
    ds_read_b128 v[168:171], v14 offset:4096
    ds_read_b128 v[172:175], v15 offset:4096
    ds_read_b128 v[236:239], v12 offset:8192
    ds_read_b128 v[240:243], v13 offset:8192
    ds_read_b128 v[244:247], v14 offset:8192
    ds_read_b128 v[248:251], v15 offset:8192
    ds_read_b128 v[176:179], v12 offset:12288
    ds_read_b128 v[180:183], v13 offset:12288
    ds_read_b128 v[184:187], v14 offset:12288
    ds_read_b128 v[188:191], v15 offset:12288
    v_lshlrev_b32 v10, 4, v0
    s_waitcnt lgkmcnt(0)
    v_pk_add_f32 v[220:221], v[220:221], v[160:161]
    v_pk_add_f32 v[222:223], v[222:223], v[162:163]
    v_pk_add_f32 v[224:225], v[224:225], v[164:165]
    v_pk_add_f32 v[226:227], v[226:227], v[166:167]
    v_pk_add_f32 v[228:229], v[228:229], v[168:169]
    v_pk_add_f32 v[230:231], v[230:231], v[170:171]
    v_pk_add_f32 v[232:233], v[232:233], v[172:173]
    v_pk_add_f32 v[234:235], v[234:235], v[174:175]
    v_pk_add_f32 v[236:237], v[236:237], v[176:177]
    v_pk_add_f32 v[238:239], v[238:239], v[178:179]
    v_pk_add_f32 v[240:241], v[240:241], v[180:181]
    v_pk_add_f32 v[242:243], v[242:243], v[182:183]
    v_pk_add_f32 v[244:245], v[244:245], v[184:185]
    v_pk_add_f32 v[246:247], v[246:247], v[186:187]
    v_pk_add_f32 v[248:249], v[248:249], v[188:189]
    v_pk_add_f32 v[250:251], v[250:251], v[190:191]
    v_cvt_pk_bf16_f32 v220, v220, v221
    v_cvt_pk_bf16_f32 v221, v222, v223
    v_cvt_pk_bf16_f32 v222, v224, v225
    v_cvt_pk_bf16_f32 v223, v226, v227
    v_cvt_pk_bf16_f32 v224, v228, v229
    v_cvt_pk_bf16_f32 v225, v230, v231
    v_cvt_pk_bf16_f32 v226, v232, v233
    v_cvt_pk_bf16_f32 v227, v234, v235
    v_cvt_pk_bf16_f32 v228, v236, v237
    v_cvt_pk_bf16_f32 v229, v238, v239
    v_cvt_pk_bf16_f32 v230, v240, v241
    v_cvt_pk_bf16_f32 v231, v242, v243
    v_cvt_pk_bf16_f32 v232, v244, v245
    v_cvt_pk_bf16_f32 v233, v246, v247
    v_cvt_pk_bf16_f32 v234, v248, v249
    v_cvt_pk_bf16_f32 v235, v250, v251
    s_nop 1
    v_mfma_f32_32x32x16_bf16 v[160:175], v[220:223], v[40:43], 0
    v_mfma_f32_32x32x16_bf16 v[160:175], v[224:227], v[44:47], v[160:175]
    v_mfma_f32_32x32x16_bf16 v[176:191], v[228:231], v[48:51], 0
    v_mfma_f32_32x32x16_bf16 v[176:191], v[232:235], v[52:55], v[176:191]
    s_nop 10
    v_add_f32 v11, 0x358637bd, v168
    v_rcp_f32 v11, v11
    s_nop 0
    v_mul_f32 v160, v11, v160
    v_mul_f32 v161, v11, v161
    v_mul_f32 v162, v11, v162
    v_mul_f32 v163, v11, v163
    v_mul_f32 v164, v11, v164
    v_mul_f32 v165, v11, v165
    v_mul_f32 v166, v11, v166
    v_mul_f32 v167, v11, v167
    v_cvt_pk_bf16_f32 v12, v160, v161
    v_cvt_pk_bf16_f32 v13, v162, v163
    v_cvt_pk_bf16_f32 v14, v164, v165
    v_cvt_pk_bf16_f32 v15, v166, v167
    buffer_store_dwordx4 v[12:15], v10, s[52:55], s71 offen offset:0 sc1
    v_add_f32 v11, 0x358637bd, v184
    v_rcp_f32 v11, v11
    s_nop 0
    v_mul_f32 v176, v11, v176
    v_mul_f32 v177, v11, v177
    v_mul_f32 v178, v11, v178
    v_mul_f32 v179, v11, v179
    v_mul_f32 v180, v11, v180
    v_mul_f32 v181, v11, v181
    v_mul_f32 v182, v11, v182
    v_mul_f32 v183, v11, v183
    v_cvt_pk_bf16_f32 v16, v176, v177
    v_cvt_pk_bf16_f32 v17, v178, v179
    v_cvt_pk_bf16_f32 v18, v180, v181
    v_cvt_pk_bf16_f32 v19, v182, v183
    buffer_store_dwordx4 v[16:19], v10, s[52:55], s71 offen offset:1024 sc1
    s_branch L_mid
L_h6:
    s_mov_b64 s[76:77], s[24:25]
    s_mov_b64 s[78:79], s[26:27]
    s_mov_b64 s[80:81], s[24:25]
    s_mov_b64 s[82:83], s[26:27]
    v_mov_b32 v56, v2
    v_mov_b32 v57, v2
    s_add_u32 s74, s61, 65536
    s_add_u32 s75, s61, 131072
    s_mov_b32 s84, 0
    s_mov_b32 s85, 65536
    s_mov_b32 s86, 131072
    s_mov_b32 s87, 196608
    s_mov_b32 s88, 262144
    s_mov_b32 s89, 327680
    s_mov_b32 s90, 393216
    s_mov_b32 s91, 458752
    s_waitcnt vmcnt(0)
    s_barrier
    s_lshr_b32 s6, s56, 1
    v_bfe_u32 v10, v0, 2, 2
    v_lshl_add_u32 v11, v20, 2, v10
    v_lshlrev_b32 v11, 7, v11
    v_lshrrev_b32 v10, 1, v10
    v_lshl_add_u32 v11, v10, 6, v11
    v_bfe_u32 v10, v0, 4, 1
    v_lshl_add_u32 v11, v10, 5, v11
    v_and_b32 v10, 1, v0
    v_lshl_add_u32 v11, v10, 4, v11
    v_bfe_u32 v10, v0, 1, 1
    v_lshl_add_u32 v11, v10, 3, v11
    s_lshl_b32 s3, s6, 5
    v_xor_b32 v11, s3, v11
    s_lshl_b32 s3, s6, 14
    v_add_u32 v16, s3, v11
    v_xor_b32 v17, 64, v16
    ds_read_b64_tr_b16 v[160:161], v16 offset:0
    ds_read_b64_tr_b16 v[162:163], v16 offset:1024
    ds_read_b64_tr_b16 v[164:165], v17 offset:0
    ds_read_b64_tr_b16 v[166:167], v17 offset:1024
    ds_read_b64_tr_b16 v[168:169], v16 offset:2048
    ds_read_b64_tr_b16 v[170:171], v16 offset:3072
    ds_read_b64_tr_b16 v[172:173], v17 offset:2048
    ds_read_b64_tr_b16 v[174:175], v17 offset:3072
    ds_read_b64_tr_b16 v[176:177], v16 offset:4096
    ds_read_b64_tr_b16 v[178:179], v16 offset:5120
    ds_read_b64_tr_b16 v[180:181], v17 offset:4096
    ds_read_b64_tr_b16 v[182:183], v17 offset:5120
    s_cmp_lg_u32 s56, 0
    s_cbranch_scc1 L_att
    s_lshl_b32 s3, s57, 8
    s_add_u32 s3, s3, 274432
    v_mov_b32 v10, 1
    s_mov_b64 exec, 1
    buffer_atomic_add v10, off, s[52:55], s3
    s_mov_b64 exec, -1
    s_branch L_att
L_h7:
    ds_read_b64_tr_b16 v[184:185], v16 offset:6144
    ds_read_b64_tr_b16 v[186:187], v16 offset:7168
    ds_read_b64_tr_b16 v[188:189], v17 offset:6144
    ds_read_b64_tr_b16 v[190:191], v17 offset:7168
    ds_read_b64_tr_b16 v[24:25], v16 offset:8192
    ds_read_b64_tr_b16 v[26:27], v16 offset:9216
    ds_read_b64_tr_b16 v[28:29], v17 offset:8192
    ds_read_b64_tr_b16 v[30:31], v17 offset:9216
    s_lshl_b32 s3, s57, 8
    s_add_u32 s3, s3, 274432
    v_mov_b32 v18, 0
    buffer_load_dword v19, v18, s[52:55], s3 offen sc1
    s_branch L_att
L_hm7:
    s_mov_b32 s65, 0x40000
    s_branch L_pc_f4b
L_p_f4b:
    buffer_load_dword v19, v18, s[52:55], s3 offen sc1
L_pc_f4b:
    s_waitcnt vmcnt(0)
    v_cmp_ne_u32 vcc, 8, v19
    s_sub_u32 s65, s65, 1
    s_cbranch_scc1 L_pd_f4b
    s_cmp_eq_u64 vcc, 0
    s_cbranch_scc1 L_pd_f4b
    s_sleep 8
    s_branch L_p_f4b
L_pd_f4b:
    ds_read_b64_tr_b16 v[40:41], v16 offset:10240
    ds_read_b64_tr_b16 v[42:43], v16 offset:11264
    ds_read_b64_tr_b16 v[44:45], v17 offset:10240
    ds_read_b64_tr_b16 v[46:47], v17 offset:11264
    ds_read_b64_tr_b16 v[48:49], v16 offset:12288
    ds_read_b64_tr_b16 v[50:51], v16 offset:13312
    ds_read_b64_tr_b16 v[52:53], v17 offset:12288
    ds_read_b64_tr_b16 v[54:55], v17 offset:13312
    s_lshl_b32 s3, s57, 16
    s_lshl_b32 s4, s59, 15
    s_add_u32 s3, s3, s4
    s_lshr_b32 s4, s56, 1
    s_lshl_b32 s4, s4, 13
    s_add_u32 s3, s3, s4
    s_add_u32 s3, s3, 3145728
    s_add_u32 s4, s3, 4096
    v_lshlrev_b32 v10, 4, v0
    buffer_load_dwordx4 v[220:223], v10, s[52:55], s3 offen offset:0 sc1
    buffer_load_dwordx4 v[224:227], v10, s[52:55], s3 offen offset:1024 sc1
    buffer_load_dwordx4 v[228:231], v10, s[52:55], s3 offen offset:2048 sc1
    buffer_load_dwordx4 v[232:235], v10, s[52:55], s3 offen offset:3072 sc1
    buffer_load_dwordx4 v[236:239], v10, s[52:55], s4 offen offset:0 sc1
    buffer_load_dwordx4 v[240:243], v10, s[52:55], s4 offen offset:1024 sc1
    buffer_load_dwordx4 v[244:247], v10, s[52:55], s4 offen offset:2048 sc1
    buffer_load_dwordx4 v[248:251], v10, s[52:55], s4 offen offset:3072 sc1
    s_branch L_mid
L_h8:
    s_nop 1
    v_mfma_f32_32x32x16_bf16 v[144:159], v[212:215], v[200:203], v[144:159]
    v_mfma_f32_32x32x16_bf16 v[144:159], v[216:219], v[204:207], v[144:159]
    ds_read_b64_tr_b16 v[120:121], v16 offset:14336
    ds_read_b64_tr_b16 v[122:123], v16 offset:15360
    ds_read_b64_tr_b16 v[124:125], v17 offset:14336
    ds_read_b64_tr_b16 v[126:127], v17 offset:15360
    v_mul_u32_u24 v10, 3, v4
    v_add_u32 v10, 98304, v10
    v_xor_b32 v11, 0x1000, v4
    v_mul_u32_u24 v11, 3, v11
    v_add_u32 v11, 98304, v11
    s_mov_b32 s3, 0x7b800000
    s_cmp_eq_u32 s62, 0
    s_nop 1
    s_barrier
    s_cbranch_scc1 L_lo
    ds_write_b128 v11, v[128:131] offset:0
    ds_write_b128 v11, v[132:135] offset:16
    ds_write_b32 v11, v136 offset:32
    s_waitcnt lgkmcnt(0)
    s_barrier
    ds_read_b128 v[64:67], v10 offset:0
    ds_read_b128 v[68:71], v10 offset:16
    ds_read_b32 v72, v10 offset:32
    s_waitcnt lgkmcnt(0)
    v_add_f32 v136, v152, v72
    v_pk_add_f32 v[128:129], v[144:145], v[64:65]
    v_pk_add_f32 v[130:131], v[146:147], v[66:67]
    v_pk_add_f32 v[132:133], v[148:149], v[68:69]
    v_pk_add_f32 v[134:135], v[150:151], v[70:71]
    s_branch L_sum
L_lo:
    ds_write_b128 v11, v[144:147] offset:0
    ds_write_b128 v11, v[148:151] offset:16
    ds_write_b32 v11, v152 offset:32
    s_waitcnt lgkmcnt(0)
    s_barrier
    ds_read_b128 v[64:67], v10 offset:0
    ds_read_b128 v[68:71], v10 offset:16
    ds_read_b32 v72, v10 offset:32
    s_waitcnt lgkmcnt(0)
    v_add_f32 v136, v136, v72
    v_pk_add_f32 v[128:129], v[128:129], v[64:65]
    v_pk_add_f32 v[130:131], v[130:131], v[66:67]
    v_pk_add_f32 v[132:133], v[132:133], v[68:69]
    v_pk_add_f32 v[134:135], v[134:135], v[70:71]
L_sum:
    v_add_f32 v10, abs(v128), abs(v129)
    v_add_f32 v10, v10, abs(v130)
    v_add_f32 v10, v10, abs(v131)
    v_add_f32 v10, v10, abs(v132)
    v_add_f32 v10, v10, abs(v133)
    v_add_f32 v10, v10, abs(v134)
    v_add_f32 v10, v10, abs(v135)
    v_add_f32 v10, v10, abs(v136)
    v_cmp_nle_f32 vcc, v10, s3
    s_cmp_lg_u64 vcc, 0
    s_cbranch_scc1 L_fb
L_fb_ret:
    v_rcp_f32 v11, v136
    v_lshlrev_b32 v10, 4, v0
    v_mul_f32 v128, v11, v128
    v_mul_f32 v129, v11, v129
    v_mul_f32 v130, v11, v130
    v_mul_f32 v131, v11, v131
    v_mul_f32 v132, v11, v132
    v_mul_f32 v133, v11, v133
    v_mul_f32 v134, v11, v134
    v_mul_f32 v135, v11, v135
    v_cvt_pk_bf16_f32 v12, v128, v129
    v_cvt_pk_bf16_f32 v13, v130, v131
    v_cvt_pk_bf16_f32 v14, v132, v133
    v_cvt_pk_bf16_f32 v15, v134, v135
    buffer_store_dwordx4 v[12:15], v10, s[52:55], s70 offen sc1
    s_lshl_b32 s3, s62, 15
    s_add_u32 s3, s3, 65536
    v_add_u32 v16, s3, v16
    v_add_u32 v17, s3, v17
    s_lshl_b32 s3, s6, 14
    s_waitcnt vmcnt(1)
    v_lshlrev_b32 v10, 4, v0
    s_lshl_b32 s4, s59, 13
    s_add_u32 s5, s3, s4
    v_add_u32 v6, s5, v10
    s_lshl_b32 s3, s57, 17
    s_lshl_b32 s4, s59, 16
    s_add_u32 s3, s3, s4
    s_lshl_b32 s4, s58, 7
    s_add_u32 s3, s3, s4
    s_lshl_b32 s4, s6, 5
    s_add_u32 s3, s3, s4
    v_lshlrev_b32 v7, 11, v21
    v_lshl_add_u32 v7, v20, 4, v7
    v_add_u32 v7, s3, v7
    ds_read_b64_tr_b16 v[128:129], v16 offset:0
    ds_read_b64_tr_b16 v[130:131], v16 offset:1024
    ds_read_b64_tr_b16 v[132:133], v17 offset:0
    ds_read_b64_tr_b16 v[134:135], v17 offset:1024
    ds_read_b64_tr_b16 v[136:137], v16 offset:2048
    ds_read_b64_tr_b16 v[138:139], v16 offset:3072
    ds_read_b64_tr_b16 v[140:141], v17 offset:2048
    ds_read_b64_tr_b16 v[142:143], v17 offset:3072
    ds_read_b64_tr_b16 v[144:145], v16 offset:4096
    ds_read_b64_tr_b16 v[146:147], v16 offset:5120
    ds_read_b64_tr_b16 v[148:149], v17 offset:4096
    ds_read_b64_tr_b16 v[150:151], v17 offset:5120
    ds_read_b64_tr_b16 v[152:153], v16 offset:6144
    ds_read_b64_tr_b16 v[154:155], v16 offset:7168
    ds_read_b64_tr_b16 v[156:157], v17 offset:6144
    ds_read_b64_tr_b16 v[158:159], v17 offset:7168
    ds_read_b64_tr_b16 v[192:193], v16 offset:8192
    ds_read_b64_tr_b16 v[194:195], v16 offset:9216
    ds_read_b64_tr_b16 v[196:197], v17 offset:8192
    ds_read_b64_tr_b16 v[198:199], v17 offset:9216
    ds_read_b64_tr_b16 v[200:201], v16 offset:10240
    ds_read_b64_tr_b16 v[202:203], v16 offset:11264
    ds_read_b64_tr_b16 v[204:205], v17 offset:10240
    ds_read_b64_tr_b16 v[206:207], v17 offset:11264
    ds_read_b64_tr_b16 v[208:209], v16 offset:12288
    ds_read_b64_tr_b16 v[210:211], v16 offset:13312
    ds_read_b64_tr_b16 v[212:213], v17 offset:12288
    ds_read_b64_tr_b16 v[214:215], v17 offset:13312
    ds_read_b64_tr_b16 v[96:97], v16 offset:14336
    ds_read_b64_tr_b16 v[98:99], v16 offset:15360
    ds_read_b64_tr_b16 v[100:101], v17 offset:14336
    ds_read_b64_tr_b16 v[102:103], v17 offset:15360
    s_lshl_b32 s3, s57, 16
    s_lshl_b32 s4, s59, 15
    s_add_u32 s3, s3, s4
    s_lshr_b32 s4, s56, 1
    s_lshl_b32 s4, s4, 13
    s_add_u32 s3, s3, s4
    s_add_u32 s3, s3, 1048576
    s_add_u32 s4, s3, 4096
    v_lshlrev_b32 v10, 4, v0
    v_xor_b32 v5, 16384, v6
    v_xor_b32 v8, 32768, v6
    v_xor_b32 v9, 49152, v6
    v_mfma_f32_32x32x16_bf16 v[80:95], v[164:167], v[220:223], 0
    v_mfma_f32_32x32x16_bf16 v[80:95], v[172:175], v[224:227], v[80:95]
    v_mfma_f32_32x32x16_bf16 v[80:95], v[180:183], v[228:231], v[80:95]
    v_mfma_f32_32x32x16_bf16 v[80:95], v[188:191], v[232:235], v[80:95]
    v_mfma_f32_32x32x16_bf16 v[80:95], v[28:31], v[236:239], v[80:95]
    v_mfma_f32_32x32x16_bf16 v[80:95], v[44:47], v[240:243], v[80:95]
    v_mfma_f32_32x32x16_bf16 v[80:95], v[52:55], v[244:247], v[80:95]
    v_mfma_f32_32x32x16_bf16 v[80:95], v[124:127], v[248:251], v[80:95]
    v_mfma_f32_32x32x16_bf16 v[64:79], v[160:163], v[220:223], 0
    v_mfma_f32_32x32x16_bf16 v[64:79], v[168:171], v[224:227], v[64:79]
    v_mfma_f32_32x32x16_bf16 v[64:79], v[176:179], v[228:231], v[64:79]
    v_mfma_f32_32x32x16_bf16 v[64:79], v[184:187], v[232:235], v[64:79]
    s_nop 7
    ds_write_b128 v8, v[80:83] offset:4096
    ds_write_b128 v8, v[84:87] offset:5120
    ds_write_b128 v9, v[88:91] offset:6144
    ds_write_b128 v9, v[92:95] offset:7168
    v_mfma_f32_32x32x16_bf16 v[64:79], v[24:27], v[236:239], v[64:79]
    v_mfma_f32_32x32x16_bf16 v[64:79], v[40:43], v[240:243], v[64:79]
    v_mfma_f32_32x32x16_bf16 v[64:79], v[48:51], v[244:247], v[64:79]
    v_mfma_f32_32x32x16_bf16 v[64:79], v[120:123], v[248:251], v[64:79]
    buffer_load_dwordx4 v[104:107], v10, s[52:55], s3 offen offset:0 sc1
    buffer_load_dwordx4 v[108:111], v10, s[52:55], s3 offen offset:1024 sc1
    buffer_load_dwordx4 v[112:115], v10, s[52:55], s3 offen offset:2048 sc1
    buffer_load_dwordx4 v[116:119], v10, s[52:55], s3 offen offset:3072 sc1
    buffer_load_dwordx4 v[32:35], v10, s[52:55], s4 offen offset:0 sc1
    buffer_load_dwordx4 v[36:39], v10, s[52:55], s4 offen offset:1024 sc1
    buffer_load_dwordx4 v[216:219], v10, s[52:55], s4 offen offset:2048 sc1
    buffer_load_dwordx4 v[252:255], v10, s[52:55], s4 offen offset:3072 sc1
    s_nop 3
    ds_write_b128 v5, v[72:75] offset:2048
    ds_write_b128 v5, v[76:79] offset:3072
    s_waitcnt lgkmcnt(0)
    s_barrier
    ds_read_b128 v[72:75], v6 offset:2048
    ds_read_b128 v[76:79], v6 offset:3072
    ds_read_b128 v[80:83], v6 offset:4096
    ds_read_b128 v[84:87], v6 offset:5120
    ds_read_b128 v[88:91], v6 offset:6144
    ds_read_b128 v[92:95], v6 offset:7168
    s_waitcnt lgkmcnt(4)
    v_pk_add_f32 v[64:65], v[64:65], v[72:73]
    v_pk_add_f32 v[66:67], v[66:67], v[74:75]
    v_pk_add_f32 v[68:69], v[68:69], v[76:77]
    v_pk_add_f32 v[70:71], v[70:71], v[78:79]
    s_waitcnt lgkmcnt(0)
    v_pk_add_f32 v[80:81], v[80:81], v[88:89]
    v_pk_add_f32 v[82:83], v[82:83], v[90:91]
    v_pk_add_f32 v[84:85], v[84:85], v[92:93]
    v_pk_add_f32 v[86:87], v[86:87], v[94:95]
    v_pk_add_f32 v[64:65], v[64:65], v[80:81]
    v_pk_add_f32 v[66:67], v[66:67], v[82:83]
    v_pk_add_f32 v[68:69], v[68:69], v[84:85]
    v_pk_add_f32 v[70:71], v[70:71], v[86:87]
    v_cvt_pk_bf16_f32 v12, v64, v65
    v_cvt_pk_bf16_f32 v13, v66, v67
    v_cvt_pk_bf16_f32 v14, v68, v69
    v_cvt_pk_bf16_f32 v15, v70, v71
    v_add_u32 v6, 65536, v6
    s_mov_b32 s65, 0x40000
L_oa:
    s_waitcnt vmcnt(0)
    v_max_u32 v11, v104, v105
    v_max3_u32 v11, v11, v106, v107
    v_max3_u32 v11, v11, v108, v109
    v_max3_u32 v11, v11, v110, v111
    v_max3_u32 v11, v11, v112, v113
    v_max3_u32 v11, v11, v114, v115
    v_max3_u32 v11, v11, v116, v117
    v_max3_u32 v11, v11, v118, v119
    v_max3_u32 v11, v11, v32, v33
    v_max3_u32 v11, v11, v34, v35
    v_max3_u32 v11, v11, v36, v37
    v_max3_u32 v11, v11, v38, v39
    v_max3_u32 v11, v11, v216, v217
    v_max3_u32 v11, v11, v218, v219
    v_max3_u32 v11, v11, v252, v253
    v_max3_u32 v11, v11, v254, v255
    v_cmp_eq_u32 vcc, -1, v11
    s_sub_u32 s65, s65, 1
    s_cbranch_scc1 L_oad
    s_cmp_eq_u64 vcc, 0
    s_cbranch_scc1 L_oad
    buffer_load_dwordx4 v[104:107], v10, s[52:55], s3 offen offset:0 sc1
    buffer_load_dwordx4 v[108:111], v10, s[52:55], s3 offen offset:1024 sc1
    buffer_load_dwordx4 v[112:115], v10, s[52:55], s3 offen offset:2048 sc1
    buffer_load_dwordx4 v[116:119], v10, s[52:55], s3 offen offset:3072 sc1
    buffer_load_dwordx4 v[32:35], v10, s[52:55], s4 offen offset:0 sc1
    buffer_load_dwordx4 v[36:39], v10, s[52:55], s4 offen offset:1024 sc1
    buffer_load_dwordx4 v[216:219], v10, s[52:55], s4 offen offset:2048 sc1
    buffer_load_dwordx4 v[252:255], v10, s[52:55], s4 offen offset:3072 sc1
    s_branch L_oa
L_oad:
    buffer_store_dwordx4 v[12:15], v7, s[44:47], 0 offen offset:1024
    v_xor_b32 v5, 16384, v6
    v_xor_b32 v8, 32768, v6
    v_xor_b32 v9, 49152, v6
    v_mfma_f32_32x32x16_bf16 v[80:95], v[132:135], v[104:107], 0
    v_mfma_f32_32x32x16_bf16 v[80:95], v[140:143], v[108:111], v[80:95]
    v_mfma_f32_32x32x16_bf16 v[80:95], v[148:151], v[112:115], v[80:95]
    v_mfma_f32_32x32x16_bf16 v[80:95], v[156:159], v[116:119], v[80:95]
    v_mfma_f32_32x32x16_bf16 v[80:95], v[196:199], v[32:35], v[80:95]
    v_mfma_f32_32x32x16_bf16 v[80:95], v[204:207], v[36:39], v[80:95]
    v_mfma_f32_32x32x16_bf16 v[80:95], v[212:215], v[216:219], v[80:95]
    v_mfma_f32_32x32x16_bf16 v[80:95], v[100:103], v[252:255], v[80:95]
    v_mfma_f32_32x32x16_bf16 v[64:79], v[128:131], v[104:107], 0
    v_mfma_f32_32x32x16_bf16 v[64:79], v[136:139], v[108:111], v[64:79]
    v_mfma_f32_32x32x16_bf16 v[64:79], v[144:147], v[112:115], v[64:79]
    v_mfma_f32_32x32x16_bf16 v[64:79], v[152:155], v[116:119], v[64:79]
    s_nop 7
    ds_write_b128 v8, v[80:83] offset:4096
    ds_write_b128 v8, v[84:87] offset:5120
    ds_write_b128 v9, v[88:91] offset:6144
    ds_write_b128 v9, v[92:95] offset:7168
    v_mfma_f32_32x32x16_bf16 v[64:79], v[192:195], v[32:35], v[64:79]
    v_mfma_f32_32x32x16_bf16 v[64:79], v[200:203], v[36:39], v[64:79]
    v_mfma_f32_32x32x16_bf16 v[64:79], v[208:211], v[216:219], v[64:79]
    v_mfma_f32_32x32x16_bf16 v[64:79], v[96:99], v[252:255], v[64:79]
    s_nop 11
    ds_write_b128 v5, v[72:75] offset:2048
    ds_write_b128 v5, v[76:79] offset:3072
    s_waitcnt lgkmcnt(0)
    s_barrier
    ds_read_b128 v[72:75], v6 offset:2048
    ds_read_b128 v[76:79], v6 offset:3072
    ds_read_b128 v[80:83], v6 offset:4096
    ds_read_b128 v[84:87], v6 offset:5120
    ds_read_b128 v[88:91], v6 offset:6144
    ds_read_b128 v[92:95], v6 offset:7168
    s_waitcnt lgkmcnt(4)
    v_pk_add_f32 v[64:65], v[64:65], v[72:73]
    v_pk_add_f32 v[66:67], v[66:67], v[74:75]
    v_pk_add_f32 v[68:69], v[68:69], v[76:77]
    v_pk_add_f32 v[70:71], v[70:71], v[78:79]
    s_waitcnt lgkmcnt(0)
    v_pk_add_f32 v[80:81], v[80:81], v[88:89]
    v_pk_add_f32 v[82:83], v[82:83], v[90:91]
    v_pk_add_f32 v[84:85], v[84:85], v[92:93]
    v_pk_add_f32 v[86:87], v[86:87], v[94:95]
    v_pk_add_f32 v[64:65], v[64:65], v[80:81]
    v_pk_add_f32 v[66:67], v[66:67], v[82:83]
    v_pk_add_f32 v[68:69], v[68:69], v[84:85]
    v_pk_add_f32 v[70:71], v[70:71], v[86:87]
    v_cvt_pk_bf16_f32 v72, v64, v65
    v_cvt_pk_bf16_f32 v73, v66, v67
    v_cvt_pk_bf16_f32 v74, v68, v69
    v_cvt_pk_bf16_f32 v75, v70, v71
    buffer_store_dwordx4 v[72:75], v7, s[44:47], 0 offen
L_end:
    s_endpgm
L_fb:
    s_cmp_eq_u32 s62, 0
    s_cbranch_scc1 L_fb0
    v_mov_b32 v32, v36
    v_mov_b32 v33, v37
    v_mov_b32 v34, v38
    v_mov_b32 v35, v39
L_fb0:
    v_lshlrev_b32 v13, 4, v0
    v_mov_b32 v14, 0xff800000
    s_mov_b32 s3, 0
L_fb1:
    buffer_load_dwordx4 v[208:211], v13, s[52:55], s3 offen sc1
    s_waitcnt vmcnt(0)
    v_mfma_f32_32x32x16_bf16 v[64:79], v[208:211], v[32:35], 0
    s_nop 11
    v_max3_f32 v10, v64, v65, v66
    v_max3_f32 v10, v10, v67, v68
    v_max3_f32 v10, v10, v69, v70
    v_max3_f32 v10, v10, v71, v72
    v_max3_f32 v10, v10, v73, v74
    v_max3_f32 v10, v10, v75, v76
    v_max3_f32 v10, v10, v77, v78
    v_max_f32 v10, v10, v79
    v_max_f32 v14, v14, v10
    s_add_u32 s3, s3, 2048
    s_cmp_lt_u32 s3, 0x20000
    s_cbranch_scc1 L_fb1
    v_mov_b32 v12, v14
    s_nop 1
    v_permlane32_swap_b32 v12, v14
    s_nop 1
    v_max_f32 v14, v12, v14
    v_sub_f32 v96, 0, v14
    v_sub_f32 v97, 0, v14
    v_sub_f32 v98, 0, v14
    v_sub_f32 v99, 0, v14
    v_sub_f32 v100, 0, v14
    v_sub_f32 v101, 0, v14
    v_sub_f32 v102, 0, v14
    v_sub_f32 v103, 0, v14
    v_sub_f32 v104, 0, v14
    v_sub_f32 v105, 0, v14
    v_sub_f32 v106, 0, v14
    v_sub_f32 v107, 0, v14
    v_sub_f32 v108, 0, v14
    v_sub_f32 v109, 0, v14
    v_sub_f32 v110, 0, v14
    v_sub_f32 v111, 0, v14
    v_mov_b32 v128, 0
    v_mov_b32 v129, 0
    v_mov_b32 v130, 0
    v_mov_b32 v131, 0
    v_mov_b32 v132, 0
    v_mov_b32 v133, 0
    v_mov_b32 v134, 0
    v_mov_b32 v135, 0
    v_mov_b32 v136, 0
    v_mov_b32 v137, 0
    v_mov_b32 v138, 0
    v_mov_b32 v139, 0
    v_mov_b32 v140, 0
    v_mov_b32 v141, 0
    v_mov_b32 v142, 0
    v_mov_b32 v143, 0
    v_and_b32 v15, 15, v0
    v_lshlrev_b32 v15, 4, v15
    v_lshl_add_u32 v15, v20, 8, v15
    s_mov_b32 s3, 0
L_fb2:
    buffer_load_dwordx4 v[208:211], v13, s[52:55], s3 offen sc1
    s_mov_b64 exec, s[68:69]
    buffer_load_dwordx4 v[212:215], v15, s[52:55], s3 offen offset:1024 sc1
    buffer_load_dwordx4 v[216:219], v15, s[52:55], s3 offen offset:1536 sc1
    s_mov_b64 exec, -1
    s_waitcnt vmcnt(0)
    v_mfma_f32_32x32x16_bf16 v[64:79], v[208:211], v[32:35], v[96:111]
    s_nop 11
    v_exp_f32 v64, v64
    v_exp_f32 v65, v65
    v_exp_f32 v66, v66
    v_exp_f32 v67, v67
    v_exp_f32 v68, v68
    v_exp_f32 v69, v69
    v_exp_f32 v70, v70
    v_exp_f32 v71, v71
    v_exp_f32 v72, v72
    v_exp_f32 v73, v73
    v_exp_f32 v74, v74
    v_exp_f32 v75, v75
    v_exp_f32 v76, v76
    v_exp_f32 v77, v77
    v_exp_f32 v78, v78
    v_exp_f32 v79, v79
    s_nop 0
    v_cvt_pk_bf16_f32 v192, v64, v65
    v_cvt_pk_bf16_f32 v193, v66, v67
    v_cvt_pk_bf16_f32 v194, v68, v69
    v_cvt_pk_bf16_f32 v195, v70, v71
    v_cvt_pk_bf16_f32 v196, v72, v73
    v_cvt_pk_bf16_f32 v197, v74, v75
    v_cvt_pk_bf16_f32 v198, v76, v77
    v_cvt_pk_bf16_f32 v199, v78, v79
    s_nop 1
    v_mfma_f32_32x32x16_bf16 v[128:143], v[212:215], v[192:195], v[128:143]
    v_mfma_f32_32x32x16_bf16 v[128:143], v[216:219], v[196:199], v[128:143]
    s_nop 11
    s_add_u32 s3, s3, 2048
    s_cmp_lt_u32 s3, 0x20000
    s_cbranch_scc1 L_fb2
    s_branch L_fb_ret
.section .rodata,"a"
.p2align 6
.amdhsa_kernel concat_heads__grouped_kv_mqa__linear_kernel_hedgehog__prompt_kernel
  .amdhsa_next_free_vgpr 256
  .amdhsa_next_free_sgpr 102
  .amdhsa_accum_offset 256
  .amdhsa_group_segment_fixed_size 0
  .amdhsa_kernarg_size 96
  .amdhsa_user_sgpr_count 2
  .amdhsa_user_sgpr_kernarg_segment_ptr 1
  .amdhsa_system_sgpr_workgroup_id_x 1
.end_amdhsa_kernel
```
